```python
import torch

def _softmax(x, axis=-1):
    return torch.softmax(x, dim=axis)
def _gelu(x):
    return torch.nn.functional.gelu(x, approximate="tanh")
def _silu(x):
    return torch.nn.functional.silu(x)
def _sigmoid(x):
    return torch.sigmoid(x)
def _layernorm(x, axis=-1, eps=1e-5):
    m = x.mean(dim=axis, keepdim=True)
    v = x.var(dim=axis, keepdim=True, unbiased=False)
    return (x - m) / torch.sqrt(v + eps)
def _scatter_add(tgt, idx, src, axis=0):
    return tgt.clone().index_add_(axis, idx, src)
def _segment_sum(src, seg, n):
    out = torch.zeros((n,) + src.shape[1:], dtype=src.dtype)
    return out.index_add_(0, seg, src)
def _pad(x, pw):
    flat = tuple(v for pair in reversed(pw) for v in pair)
    return torch.nn.functional.pad(x, flat)

kernel_name = 'standalone__gqa_softmax__near_ridge'

def setup_inputs():

    _w = (lambda a: (lambda t: t.to(torch.bfloat16) if t.is_floating_point() else t)(torch.as_tensor(a)))
    B, Hq, Hkv, Sq, Sk, D = 8, 32, 32, 256, 1024, 128
    return {
        "q": _w((lambda *s: torch.randn(*s, dtype=torch.bfloat16) * 0.8)(B, Hq, Sq, D)),
        "k": _w((lambda *s: torch.randn(*s, dtype=torch.bfloat16) * 0.8)(B, Hkv, Sk, D)),
        "v": _w((lambda *s: torch.randn(*s, dtype=torch.bfloat16) * 0.05)(B, Hkv, Sk, D)),
    }

def reference(q, k, v):
    B, Hq, Sq, D = q.shape
    Hkv = k.shape[1]
    rep = Hq // Hkv
    k = (lambda x, n, axis: torch.repeat_interleave(x, n, dim=axis))(k, rep, axis=1)
    v = (lambda x, n, axis: torch.repeat_interleave(x, n, dim=axis))(v, rep, axis=1)
    scale = D ** -0.5
    scores = torch.einsum("bhqd,bhkd->bhqk", q, k) * scale
    p = _softmax(scores, axis=-1)
    return torch.einsum("bhqk,bhkd->bhqd", p, v)
```

```asm
; @launch grid=(256,1,1) block=(256,1,1) lds=99840
.amdgcn_target "amdgcn-amd-amdhsa--gfx950"
.text
.globl standalone__gqa_softmax__near_ridge_kernel
.p2align 8
.type standalone__gqa_softmax__near_ridge_kernel,@function
standalone__gqa_softmax__near_ridge_kernel:
    s_cmp_ge_u32 s2, 256
    s_cbranch_scc1 L_end
    s_load_dwordx8 s[36:43], s[0:1], 0
    s_getpc_b64 s[46:47]
L_pc:
    v_lshlrev_b32 v229, 7, v0
    v_min_u32 v229, L_end-L_pc, v229
    global_load_dword v251, v229, s[46:47]
    v_lshrrev_b32 v228, 6, v0
    v_and_b32 v245, 63, v0
    v_readfirstlane_b32 s24, v228
    v_lshlrev_b32 v229, 4, v245
    v_and_b32 v230, 48, v245
    v_lshlrev_b32 v230, 2, v230
    v_xor_b32 v191, v230, v229
    v_lshl_add_u32 v244, v228, 12, v229
    s_lshl_b32 s50, s2, 16
    s_lshl_b32 s51, s2, 18
    s_mov_b32 s10, 0x10000
    s_mov_b32 s11, 0x20000
    s_mov_b32 s14, 0x40000
    s_mov_b32 s15, 0x20000
    s_mul_i32 s25, s24, 4160
    s_lshl_b32 s52, s24, 14
    s_waitcnt lgkmcnt(0)
    s_add_u32 s8, s36, s50
    s_addc_u32 s9, s37, 0
    s_add_u32 m0, s25, 0
    s_add_u32 s54, s52, 0
    buffer_load_dwordx4 v191, s[8:11], s54 offen nt lds
    s_add_u32 m0, s25, 16
    s_nop 0
    buffer_load_dwordx4 v191, s[8:11], s54 offen offset:1024 nt lds
    s_add_u32 m0, s25, 32
    s_nop 0
    buffer_load_dwordx4 v191, s[8:11], s54 offen offset:2048 nt lds
    s_add_u32 m0, s25, 48
    s_nop 0
    buffer_load_dwordx4 v191, s[8:11], s54 offen offset:3072 nt lds
    s_add_u32 s12, s38, s51
    s_addc_u32 s13, s39, 0
    s_add_u32 m0, s25, 49920
    s_mov_b32 s54, 0
    buffer_load_dwordx4 v244, s[12:15], s54 offen nt lds
    s_add_u32 m0, s25, 49936
    s_nop 0
    buffer_load_dwordx4 v244, s[12:15], s54 offen offset:1024 nt lds
    s_add_u32 m0, s25, 49952
    s_nop 0
    buffer_load_dwordx4 v244, s[12:15], s54 offen offset:2048 nt lds
    s_add_u32 m0, s25, 49968
    s_nop 0
    buffer_load_dwordx4 v244, s[12:15], s54 offen offset:3072 nt lds
    s_mov_b32 s18, 0x40000
    s_mov_b32 s19, 0x20000
    s_mov_b32 s22, 0x10000
    s_mov_b32 s23, 0x20000
    s_add_u32 s16, s40, s51
    s_addc_u32 s17, s41, 0
    s_add_u32 s20, s42, s50
    s_addc_u32 s21, s43, 0
    v_mov_b32 v208, 0
    v_mov_b32 v209, 0
    v_mov_b32 v210, 0
    v_mov_b32 v211, 0
    v_mov_b32 v212, 0
    v_mov_b32 v213, 0
    v_mov_b32 v214, 0
    v_mov_b32 v215, 0
    v_mov_b32 v216, 0
    v_mov_b32 v217, 0
    v_mov_b32 v218, 0
    v_mov_b32 v219, 0
    v_mov_b32 v220, 0
    v_mov_b32 v221, 0
    v_mov_b32 v222, 0
    v_mov_b32 v223, 0
    v_and_b32 v230, 3, v245
    v_bfe_u32 v231, v245, 2, 2
    v_lshrrev_b32 v234, 4, v245
    v_mfma_f32_32x32x16_bf16 a[0:15], v[208:211], v[208:211], 0
    v_mfma_f32_32x32x16_bf16 a[16:31], v[208:211], v[208:211], 0
    v_mfma_f32_32x32x16_bf16 a[32:47], v[208:211], v[208:211], 0
    v_mfma_f32_32x32x16_bf16 a[48:63], v[208:211], v[208:211], 0
    v_mfma_f32_32x32x16_bf16 a[64:79], v[208:211], v[208:211], 0
    v_mfma_f32_32x32x16_bf16 a[80:95], v[208:211], v[208:211], 0
    v_mfma_f32_32x32x16_bf16 a[96:111], v[208:211], v[208:211], 0
    v_mfma_f32_32x32x16_bf16 a[112:127], v[208:211], v[208:211], 0
    v_bfe_u32 v232, v245, 2, 1
    v_bfe_u32 v233, v245, 3, 1
    v_lshl_add_u32 v232, v232, 1, v233
    v_lshl_add_u32 v232, v230, 2, v232
    v_mul_u32_u24 v242, 1040, v232
    v_lshl_add_u32 v242, v234, 6, v242
    v_bfe_u32 v232, v245, 4, 1
    v_bfe_u32 v233, v245, 5, 1
    v_lshl_add_u32 v232, v232, 1, v233
    v_lshl_add_u32 v232, v231, 2, v232
    v_mul_u32_u24 v243, 1040, v232
    v_lshl_add_u32 v243, v230, 3, v243
    v_add_u32 v240, 49920, v242
    v_add_u32 v241, 0, v243
    v_mul_u32_u24 v232, 1040, v231
    v_lshl_add_u32 v232, v230, 8, v232
    v_xor_b32 v233, v234, v230
    v_lshl_add_u32 v232, v233, 6, v232
    v_add_u32 v232, s25, v232
    v_add_u32 v187, 0, v232
    v_add_u32 v188, 16640, v232
    v_add_u32 v189, 33280, v232
    v_add_u32 v190, 66560, v232
    s_mov_b32 s34, 0x3e0293ee
    s_mov_b32 s35, 0x3e0293ee
    s_mov_b32 s28, 0x49800000
    s_add_u32 s26, s25, 99840
    v_cmp_gt_u32 vcc, 2, v230
    v_mov_b32 v233, 0x3f803f80
    s_add_u32 s32, s25, 33280
    s_add_u32 s33, s25, 49920
    s_add_u32 s30, s25, 0
    s_add_u32 s31, s25, 16640
    s_mov_b32 s27, 98304
    v_cndmask_b32 v236, 0, v233, vcc
    v_cndmask_b32 v237, 0, v233, vcc
    v_cndmask_b32 v238, 0, v233, vcc
    v_cndmask_b32 v239, 0, v233, vcc
    v_and_b32 v233, 1, v245
    v_mul_u32_u24 v233, 0xaaaa, v233
    v_or_b32 v233, 0x4444, v233
    v_lshl_or_b32 v245, v233, 16, v233
    s_waitcnt vmcnt(4)
    ds_read_b128 v[64:67], v187 offset:0
    ds_read_b128 v[68:71], v187 offset:16
    ds_read_b128 v[72:75], v187 offset:32
    ds_read_b128 v[76:79], v187 offset:48
    s_add_u32 m0, s25, 16640
    s_add_u32 s54, s52, 4096
    buffer_load_dwordx4 v191, s[8:11], s54 offen nt lds
    s_add_u32 m0, s25, 16656
    s_nop 0
    buffer_load_dwordx4 v191, s[8:11], s54 offen offset:1024 nt lds
    s_add_u32 m0, s25, 16672
    s_nop 0
    buffer_load_dwordx4 v191, s[8:11], s54 offen offset:2048 nt lds
    s_add_u32 m0, s25, 16688
    s_nop 0
    buffer_load_dwordx4 v191, s[8:11], s54 offen offset:3072 nt lds
    s_waitcnt lgkmcnt(3)
    v_lshlrev_b32 v176, 16, v64
    v_and_b32 v177, 0xffff0000, v64
    v_lshlrev_b32 v178, 16, v65
    v_and_b32 v179, 0xffff0000, v65
    v_lshlrev_b32 v180, 16, v66
    v_and_b32 v181, 0xffff0000, v66
    v_lshlrev_b32 v182, 16, v67
    v_and_b32 v183, 0xffff0000, v67
    v_pk_mul_f32 v[176:177], v[176:177], s[34:35]
    v_pk_mul_f32 v[178:179], v[178:179], s[34:35]
    v_pk_mul_f32 v[180:181], v[180:181], s[34:35]
    v_pk_mul_f32 v[182:183], v[182:183], s[34:35]
    v_cvt_pk_bf16_f32 v160, v176, v177
    v_cvt_pk_bf16_f32 v161, v178, v179
    v_cvt_pk_bf16_f32 v162, v180, v181
    v_cvt_pk_bf16_f32 v163, v182, v183
    s_waitcnt lgkmcnt(2)
    v_lshlrev_b32 v176, 16, v68
    v_and_b32 v177, 0xffff0000, v68
    v_lshlrev_b32 v178, 16, v69
    v_and_b32 v179, 0xffff0000, v69
    v_lshlrev_b32 v180, 16, v70
    v_and_b32 v181, 0xffff0000, v70
    v_lshlrev_b32 v182, 16, v71
    v_and_b32 v183, 0xffff0000, v71
    v_pk_mul_f32 v[176:177], v[176:177], s[34:35]
    v_pk_mul_f32 v[178:179], v[178:179], s[34:35]
    v_pk_mul_f32 v[180:181], v[180:181], s[34:35]
    v_pk_mul_f32 v[182:183], v[182:183], s[34:35]
    v_cvt_pk_bf16_f32 v164, v176, v177
    v_cvt_pk_bf16_f32 v165, v178, v179
    v_cvt_pk_bf16_f32 v166, v180, v181
    v_cvt_pk_bf16_f32 v167, v182, v183
    s_waitcnt lgkmcnt(1)
    v_lshlrev_b32 v176, 16, v72
    v_and_b32 v177, 0xffff0000, v72
    v_lshlrev_b32 v178, 16, v73
    v_and_b32 v179, 0xffff0000, v73
    v_lshlrev_b32 v180, 16, v74
    v_and_b32 v181, 0xffff0000, v74
    v_lshlrev_b32 v182, 16, v75
    v_and_b32 v183, 0xffff0000, v75
    v_pk_mul_f32 v[176:177], v[176:177], s[34:35]
    v_pk_mul_f32 v[178:179], v[178:179], s[34:35]
    v_pk_mul_f32 v[180:181], v[180:181], s[34:35]
    v_pk_mul_f32 v[182:183], v[182:183], s[34:35]
    v_cvt_pk_bf16_f32 v168, v176, v177
    v_cvt_pk_bf16_f32 v169, v178, v179
    v_cvt_pk_bf16_f32 v170, v180, v181
    v_cvt_pk_bf16_f32 v171, v182, v183
    s_waitcnt lgkmcnt(0)
    v_lshlrev_b32 v176, 16, v76
    v_and_b32 v177, 0xffff0000, v76
    v_lshlrev_b32 v178, 16, v77
    v_and_b32 v179, 0xffff0000, v77
    v_lshlrev_b32 v180, 16, v78
    v_and_b32 v181, 0xffff0000, v78
    v_lshlrev_b32 v182, 16, v79
    v_and_b32 v183, 0xffff0000, v79
    v_pk_mul_f32 v[176:177], v[176:177], s[34:35]
    v_pk_mul_f32 v[178:179], v[178:179], s[34:35]
    v_pk_mul_f32 v[180:181], v[180:181], s[34:35]
    v_pk_mul_f32 v[182:183], v[182:183], s[34:35]
    v_cvt_pk_bf16_f32 v172, v176, v177
    v_cvt_pk_bf16_f32 v173, v178, v179
    v_cvt_pk_bf16_f32 v174, v180, v181
    v_cvt_pk_bf16_f32 v175, v182, v183
    s_waitcnt vmcnt(4)
    s_barrier
    ds_read_b128 a[192:195], v240 offset:0
    ds_read_b128 a[196:199], v240 offset:16
    ds_read_b128 a[200:203], v240 offset:32
    ds_read_b128 a[204:207], v240 offset:48
    ds_read_b128 a[208:211], v240 offset:256
    ds_read_b128 a[212:215], v240 offset:272
    ds_read_b128 a[216:219], v240 offset:288
    ds_read_b128 a[220:223], v240 offset:304
    ds_read_b128 a[224:227], v240 offset:512
    ds_read_b128 a[228:231], v240 offset:528
    ds_read_b128 a[232:235], v240 offset:544
    ds_read_b128 a[236:239], v240 offset:560
    ds_read_b128 a[240:243], v240 offset:768
    ds_read_b128 a[244:247], v240 offset:784
    ds_read_b128 a[248:251], v240 offset:800
    ds_read_b128 a[252:255], v240 offset:816
    v_add_u32 v240, 83200, v242
    s_add_u32 m0, s25, 33280
    s_add_u32 s54, s52, 8192
    buffer_load_dwordx4 v191, s[8:11], s54 offen nt lds
    s_add_u32 m0, s25, 33296
    s_nop 0
    buffer_load_dwordx4 v191, s[8:11], s54 offen offset:1024 nt lds
    s_add_u32 m0, s25, 33312
    s_nop 0
    buffer_load_dwordx4 v191, s[8:11], s54 offen offset:2048 nt lds
    s_add_u32 m0, s25, 33328
    s_nop 0
    buffer_load_dwordx4 v191, s[8:11], s54 offen offset:3072 nt lds
    s_waitcnt lgkmcnt(0)
    v_mfma_f32_16x16x32_bf16 v[0:3], a[192:195], v[160:163], 0
    v_mfma_f32_16x16x32_bf16 v[0:3], a[196:199], v[164:167], v[0:3]
    v_mfma_f32_16x16x32_bf16 v[0:3], a[200:203], v[168:171], v[0:3]
    v_mfma_f32_16x16x32_bf16 v[0:3], a[204:207], v[172:175], v[0:3]
    v_mfma_f32_16x16x32_bf16 v[16:19], a[208:211], v[160:163], 0
    v_mfma_f32_16x16x32_bf16 v[16:19], a[212:215], v[164:167], v[16:19]
    v_accvgpr_write_b32 a128, v160
    v_mfma_f32_16x16x32_bf16 v[16:19], a[216:219], v[168:171], v[16:19]
    v_accvgpr_write_b32 a129, v161
    v_mfma_f32_16x16x32_bf16 v[16:19], a[220:223], v[172:175], v[16:19]
    v_accvgpr_write_b32 a130, v162
    v_mfma_f32_16x16x32_bf16 v[32:35], a[224:227], v[160:163], 0
    v_accvgpr_write_b32 a131, v163
    v_mfma_f32_16x16x32_bf16 v[32:35], a[228:231], v[164:167], v[32:35]
    v_accvgpr_write_b32 a132, v164
    v_mfma_f32_16x16x32_bf16 v[32:35], a[232:235], v[168:171], v[32:35]
    v_accvgpr_write_b32 a133, v165
    v_mfma_f32_16x16x32_bf16 v[32:35], a[236:239], v[172:175], v[32:35]
    v_accvgpr_write_b32 a134, v166
    v_mfma_f32_16x16x32_bf16 v[48:51], a[240:243], v[160:163], 0
    v_max3_f32 v246, v0, v1, v2
    v_accvgpr_write_b32 a135, v167
    v_mfma_f32_16x16x32_bf16 v[48:51], a[244:247], v[164:167], v[48:51]
    v_max3_f32 v246, v246, v3, v16
    v_accvgpr_write_b32 a136, v168
    v_mfma_f32_16x16x32_bf16 v[48:51], a[248:251], v[168:171], v[48:51]
    v_max3_f32 v246, v246, v17, v18
    v_accvgpr_write_b32 a137, v169
    v_mfma_f32_16x16x32_bf16 v[48:51], a[252:255], v[172:175], v[48:51]
    v_max3_f32 v246, v246, v19, v32
    v_accvgpr_write_b32 a138, v170
    v_max3_f32 v246, v246, v33, v34
    v_accvgpr_write_b32 a139, v171
    v_accvgpr_write_b32 a140, v172
    v_accvgpr_write_b32 a141, v173
    v_accvgpr_write_b32 a142, v174
    v_accvgpr_write_b32 a143, v175
    v_max3_f32 v246, v246, v35, v48
    v_max3_f32 v246, v246, v49, v50
    v_max_f32 v246, v246, v51
    v_mov_b32 v247, v246
    s_nop 1
    v_permlane32_swap_b32 v246, v247
    s_nop 1
    v_max_f32 v246, v246, v247
    v_mov_b32 v247, v246
    s_nop 1
    v_permlane16_swap_b32 v246, v247
    s_nop 1
    v_max_f32 v246, v246, v247
    v_sub_f32 v0, v0, v246
    v_sub_f32 v1, v1, v246
    v_sub_f32 v2, v2, v246
    v_sub_f32 v3, v3, v246
    v_sub_f32 v16, v16, v246
    v_sub_f32 v17, v17, v246
    v_sub_f32 v18, v18, v246
    v_sub_f32 v19, v19, v246
    v_sub_f32 v32, v32, v246
    v_sub_f32 v33, v33, v246
    v_sub_f32 v34, v34, v246
    v_sub_f32 v35, v35, v246
    v_sub_f32 v48, v48, v246
    v_sub_f32 v49, v49, v246
    v_sub_f32 v50, v50, v246
    v_sub_f32 v51, v51, v246
    v_exp_f32 v0, v0
    v_exp_f32 v1, v1
    v_exp_f32 v2, v2
    v_exp_f32 v3, v3
    v_exp_f32 v16, v16
    v_exp_f32 v17, v17
    v_exp_f32 v18, v18
    v_exp_f32 v19, v19
    v_exp_f32 v32, v32
    v_exp_f32 v33, v33
    v_exp_f32 v34, v34
    v_exp_f32 v35, v35
    v_exp_f32 v48, v48
    v_exp_f32 v49, v49
    v_exp_f32 v50, v50
    v_exp_f32 v51, v51
    v_cvt_pk_bf16_f32 v128, v0, v1
    v_cvt_pk_bf16_f32 v129, v2, v3
    v_cvt_pk_bf16_f32 v130, v16, v17
    v_cvt_pk_bf16_f32 v131, v18, v19
    v_cvt_pk_bf16_f32 v132, v32, v33
    v_cvt_pk_bf16_f32 v133, v34, v35
    v_cvt_pk_bf16_f32 v134, v48, v49
    v_cvt_pk_bf16_f32 v135, v50, v51
    v_sub_f32 v192, 0, v246
    v_sub_f32 v193, 0, v246
    v_sub_f32 v194, 0, v246
    v_sub_f32 v195, 0, v246
    v_smfmac_f32_16x16x64_bf16 v[208:211], v[236:239], v[128:135], v245
    s_waitcnt vmcnt(4)
    ds_read_b128 v[80:83], v188 offset:0
    ds_read_b128 v[84:87], v188 offset:16
    ds_read_b128 v[88:91], v188 offset:32
    ds_read_b128 v[92:95], v188 offset:48
    s_add_u32 m0, s25, 66560
    s_add_u32 s54, s52, 12288
    buffer_load_dwordx4 v191, s[8:11], s54 offen nt lds
    s_add_u32 m0, s25, 66576
    s_nop 0
    buffer_load_dwordx4 v191, s[8:11], s54 offen offset:1024 nt lds
    s_add_u32 m0, s25, 66592
    s_nop 0
    buffer_load_dwordx4 v191, s[8:11], s54 offen offset:2048 nt lds
    s_add_u32 m0, s25, 66608
    s_nop 0
    buffer_load_dwordx4 v191, s[8:11], s54 offen offset:3072 nt lds
    s_waitcnt lgkmcnt(3)
    v_lshlrev_b32 v176, 16, v80
    v_and_b32 v177, 0xffff0000, v80
    v_lshlrev_b32 v178, 16, v81
    v_and_b32 v179, 0xffff0000, v81
    v_lshlrev_b32 v180, 16, v82
    v_and_b32 v181, 0xffff0000, v82
    v_lshlrev_b32 v182, 16, v83
    v_and_b32 v183, 0xffff0000, v83
    v_pk_mul_f32 v[176:177], v[176:177], s[34:35]
    v_pk_mul_f32 v[178:179], v[178:179], s[34:35]
    v_pk_mul_f32 v[180:181], v[180:181], s[34:35]
    v_pk_mul_f32 v[182:183], v[182:183], s[34:35]
    v_cvt_pk_bf16_f32 v160, v176, v177
    v_cvt_pk_bf16_f32 v161, v178, v179
    v_cvt_pk_bf16_f32 v162, v180, v181
    v_cvt_pk_bf16_f32 v163, v182, v183
    s_waitcnt lgkmcnt(2)
    v_lshlrev_b32 v176, 16, v84
    v_and_b32 v177, 0xffff0000, v84
    v_lshlrev_b32 v178, 16, v85
    v_and_b32 v179, 0xffff0000, v85
    v_lshlrev_b32 v180, 16, v86
    v_and_b32 v181, 0xffff0000, v86
    v_lshlrev_b32 v182, 16, v87
    v_and_b32 v183, 0xffff0000, v87
    v_pk_mul_f32 v[176:177], v[176:177], s[34:35]
    v_pk_mul_f32 v[178:179], v[178:179], s[34:35]
    v_pk_mul_f32 v[180:181], v[180:181], s[34:35]
    v_pk_mul_f32 v[182:183], v[182:183], s[34:35]
    v_cvt_pk_bf16_f32 v164, v176, v177
    v_cvt_pk_bf16_f32 v165, v178, v179
    v_cvt_pk_bf16_f32 v166, v180, v181
    v_cvt_pk_bf16_f32 v167, v182, v183
    s_waitcnt lgkmcnt(1)
    v_lshlrev_b32 v176, 16, v88
    v_and_b32 v177, 0xffff0000, v88
    v_lshlrev_b32 v178, 16, v89
    v_and_b32 v179, 0xffff0000, v89
    v_lshlrev_b32 v180, 16, v90
    v_and_b32 v181, 0xffff0000, v90
    v_lshlrev_b32 v182, 16, v91
    v_and_b32 v183, 0xffff0000, v91
    v_pk_mul_f32 v[176:177], v[176:177], s[34:35]
    v_pk_mul_f32 v[178:179], v[178:179], s[34:35]
    v_pk_mul_f32 v[180:181], v[180:181], s[34:35]
    v_pk_mul_f32 v[182:183], v[182:183], s[34:35]
    v_cvt_pk_bf16_f32 v168, v176, v177
    v_cvt_pk_bf16_f32 v169, v178, v179
    v_cvt_pk_bf16_f32 v170, v180, v181
    v_cvt_pk_bf16_f32 v171, v182, v183
    s_waitcnt lgkmcnt(0)
    v_lshlrev_b32 v176, 16, v92
    v_and_b32 v177, 0xffff0000, v92
    v_lshlrev_b32 v178, 16, v93
    v_and_b32 v179, 0xffff0000, v93
    v_lshlrev_b32 v180, 16, v94
    v_and_b32 v181, 0xffff0000, v94
    v_lshlrev_b32 v182, 16, v95
    v_and_b32 v183, 0xffff0000, v95
    v_pk_mul_f32 v[176:177], v[176:177], s[34:35]
    v_pk_mul_f32 v[178:179], v[178:179], s[34:35]
    v_pk_mul_f32 v[180:181], v[180:181], s[34:35]
    v_pk_mul_f32 v[182:183], v[182:183], s[34:35]
    v_cvt_pk_bf16_f32 v172, v176, v177
    v_cvt_pk_bf16_f32 v173, v178, v179
    v_cvt_pk_bf16_f32 v174, v180, v181
    v_cvt_pk_bf16_f32 v175, v182, v183
    v_mfma_f32_16x16x32_bf16 v[4:7], a[192:195], v[160:163], 0
    v_mfma_f32_16x16x32_bf16 v[4:7], a[196:199], v[164:167], v[4:7]
    v_mfma_f32_16x16x32_bf16 v[4:7], a[200:203], v[168:171], v[4:7]
    v_mfma_f32_16x16x32_bf16 v[4:7], a[204:207], v[172:175], v[4:7]
    v_mfma_f32_16x16x32_bf16 v[20:23], a[208:211], v[160:163], 0
    v_mfma_f32_16x16x32_bf16 v[20:23], a[212:215], v[164:167], v[20:23]
    v_accvgpr_write_b32 a144, v160
    v_mfma_f32_16x16x32_bf16 v[20:23], a[216:219], v[168:171], v[20:23]
    v_accvgpr_write_b32 a145, v161
    v_mfma_f32_16x16x32_bf16 v[20:23], a[220:223], v[172:175], v[20:23]
    v_accvgpr_write_b32 a146, v162
    v_mfma_f32_16x16x32_bf16 v[36:39], a[224:227], v[160:163], 0
    v_accvgpr_write_b32 a147, v163
    v_mfma_f32_16x16x32_bf16 v[36:39], a[228:231], v[164:167], v[36:39]
    v_accvgpr_write_b32 a148, v164
    v_mfma_f32_16x16x32_bf16 v[36:39], a[232:235], v[168:171], v[36:39]
    v_accvgpr_write_b32 a149, v165
    v_mfma_f32_16x16x32_bf16 v[36:39], a[236:239], v[172:175], v[36:39]
    v_accvgpr_write_b32 a150, v166
    v_mfma_f32_16x16x32_bf16 v[52:55], a[240:243], v[160:163], 0
    v_max3_f32 v246, v4, v5, v6
    v_accvgpr_write_b32 a151, v167
    v_mfma_f32_16x16x32_bf16 v[52:55], a[244:247], v[164:167], v[52:55]
    v_max3_f32 v246, v246, v7, v20
    v_accvgpr_write_b32 a152, v168
    v_mfma_f32_16x16x32_bf16 v[52:55], a[248:251], v[168:171], v[52:55]
    v_max3_f32 v246, v246, v21, v22
    v_accvgpr_write_b32 a153, v169
    v_mfma_f32_16x16x32_bf16 v[52:55], a[252:255], v[172:175], v[52:55]
    v_max3_f32 v246, v246, v23, v36
    v_accvgpr_write_b32 a154, v170
    v_max3_f32 v246, v246, v37, v38
    v_accvgpr_write_b32 a155, v171
    v_accvgpr_write_b32 a156, v172
    v_accvgpr_write_b32 a157, v173
    v_accvgpr_write_b32 a158, v174
    v_accvgpr_write_b32 a159, v175
    v_max3_f32 v246, v246, v39, v52
    v_max3_f32 v246, v246, v53, v54
    v_max_f32 v246, v246, v55
    v_mov_b32 v247, v246
    s_nop 1
    v_permlane32_swap_b32 v246, v247
    s_nop 1
    v_max_f32 v246, v246, v247
    v_mov_b32 v247, v246
    s_nop 1
    v_permlane16_swap_b32 v246, v247
    s_nop 1
    v_max_f32 v246, v246, v247
    v_sub_f32 v4, v4, v246
    v_sub_f32 v5, v5, v246
    v_sub_f32 v6, v6, v246
    v_sub_f32 v7, v7, v246
    v_sub_f32 v20, v20, v246
    v_sub_f32 v21, v21, v246
    v_sub_f32 v22, v22, v246
    v_sub_f32 v23, v23, v246
    v_sub_f32 v36, v36, v246
    v_sub_f32 v37, v37, v246
    v_sub_f32 v38, v38, v246
    v_sub_f32 v39, v39, v246
    v_sub_f32 v52, v52, v246
    v_sub_f32 v53, v53, v246
    v_sub_f32 v54, v54, v246
    v_sub_f32 v55, v55, v246
    v_exp_f32 v4, v4
    v_exp_f32 v5, v5
    v_exp_f32 v6, v6
    v_exp_f32 v7, v7
    v_exp_f32 v20, v20
    v_exp_f32 v21, v21
    v_exp_f32 v22, v22
    v_exp_f32 v23, v23
    v_exp_f32 v36, v36
    v_exp_f32 v37, v37
    v_exp_f32 v38, v38
    v_exp_f32 v39, v39
    v_exp_f32 v52, v52
    v_exp_f32 v53, v53
    v_exp_f32 v54, v54
    v_exp_f32 v55, v55
    v_cvt_pk_bf16_f32 v136, v4, v5
    v_cvt_pk_bf16_f32 v137, v6, v7
    v_cvt_pk_bf16_f32 v138, v20, v21
    v_cvt_pk_bf16_f32 v139, v22, v23
    v_cvt_pk_bf16_f32 v140, v36, v37
    v_cvt_pk_bf16_f32 v141, v38, v39
    v_cvt_pk_bf16_f32 v142, v52, v53
    v_cvt_pk_bf16_f32 v143, v54, v55
    v_sub_f32 v196, 0, v246
    v_sub_f32 v197, 0, v246
    v_sub_f32 v198, 0, v246
    v_sub_f32 v199, 0, v246
    v_smfmac_f32_16x16x64_bf16 v[212:215], v[236:239], v[136:143], v245
    s_waitcnt vmcnt(4)
    ds_read_b128 v[96:99], v189 offset:0
    ds_read_b128 v[100:103], v189 offset:16
    ds_read_b128 v[104:107], v189 offset:32
    ds_read_b128 v[108:111], v189 offset:48
    s_add_u32 m0, s25, 83200
    s_mov_b32 s54, 16384
    buffer_load_dwordx4 v244, s[12:15], s54 offen nt lds
    s_add_u32 m0, s25, 83216
    s_nop 0
    buffer_load_dwordx4 v244, s[12:15], s54 offen offset:1024 nt lds
    s_add_u32 m0, s25, 83232
    s_nop 0
    buffer_load_dwordx4 v244, s[12:15], s54 offen offset:2048 nt lds
    s_add_u32 m0, s25, 83248
    s_nop 0
    buffer_load_dwordx4 v244, s[12:15], s54 offen offset:3072 nt lds
    s_waitcnt lgkmcnt(3)
    v_lshlrev_b32 v176, 16, v96
    v_and_b32 v177, 0xffff0000, v96
    v_lshlrev_b32 v178, 16, v97
    v_and_b32 v179, 0xffff0000, v97
    v_lshlrev_b32 v180, 16, v98
    v_and_b32 v181, 0xffff0000, v98
    v_lshlrev_b32 v182, 16, v99
    v_and_b32 v183, 0xffff0000, v99
    v_pk_mul_f32 v[176:177], v[176:177], s[34:35]
    v_pk_mul_f32 v[178:179], v[178:179], s[34:35]
    v_pk_mul_f32 v[180:181], v[180:181], s[34:35]
    v_pk_mul_f32 v[182:183], v[182:183], s[34:35]
    v_cvt_pk_bf16_f32 v160, v176, v177
    v_cvt_pk_bf16_f32 v161, v178, v179
    v_cvt_pk_bf16_f32 v162, v180, v181
    v_cvt_pk_bf16_f32 v163, v182, v183
    s_waitcnt lgkmcnt(2)
    v_lshlrev_b32 v176, 16, v100
    v_and_b32 v177, 0xffff0000, v100
    v_lshlrev_b32 v178, 16, v101
    v_and_b32 v179, 0xffff0000, v101
    v_lshlrev_b32 v180, 16, v102
    v_and_b32 v181, 0xffff0000, v102
    v_lshlrev_b32 v182, 16, v103
    v_and_b32 v183, 0xffff0000, v103
    v_pk_mul_f32 v[176:177], v[176:177], s[34:35]
    v_pk_mul_f32 v[178:179], v[178:179], s[34:35]
    v_pk_mul_f32 v[180:181], v[180:181], s[34:35]
    v_pk_mul_f32 v[182:183], v[182:183], s[34:35]
    v_cvt_pk_bf16_f32 v164, v176, v177
    v_cvt_pk_bf16_f32 v165, v178, v179
    v_cvt_pk_bf16_f32 v166, v180, v181
    v_cvt_pk_bf16_f32 v167, v182, v183
    s_waitcnt lgkmcnt(1)
    v_lshlrev_b32 v176, 16, v104
    v_and_b32 v177, 0xffff0000, v104
    v_lshlrev_b32 v178, 16, v105
    v_and_b32 v179, 0xffff0000, v105
    v_lshlrev_b32 v180, 16, v106
    v_and_b32 v181, 0xffff0000, v106
    v_lshlrev_b32 v182, 16, v107
    v_and_b32 v183, 0xffff0000, v107
    v_pk_mul_f32 v[176:177], v[176:177], s[34:35]
    v_pk_mul_f32 v[178:179], v[178:179], s[34:35]
    v_pk_mul_f32 v[180:181], v[180:181], s[34:35]
    v_pk_mul_f32 v[182:183], v[182:183], s[34:35]
    v_cvt_pk_bf16_f32 v168, v176, v177
    v_cvt_pk_bf16_f32 v169, v178, v179
    v_cvt_pk_bf16_f32 v170, v180, v181
    v_cvt_pk_bf16_f32 v171, v182, v183
    s_waitcnt lgkmcnt(0)
    v_lshlrev_b32 v176, 16, v108
    v_and_b32 v177, 0xffff0000, v108
    v_lshlrev_b32 v178, 16, v109
    v_and_b32 v179, 0xffff0000, v109
    v_lshlrev_b32 v180, 16, v110
    v_and_b32 v181, 0xffff0000, v110
    v_lshlrev_b32 v182, 16, v111
    v_and_b32 v183, 0xffff0000, v111
    v_pk_mul_f32 v[176:177], v[176:177], s[34:35]
    v_pk_mul_f32 v[178:179], v[178:179], s[34:35]
    v_pk_mul_f32 v[180:181], v[180:181], s[34:35]
    v_pk_mul_f32 v[182:183], v[182:183], s[34:35]
    v_cvt_pk_bf16_f32 v172, v176, v177
    v_cvt_pk_bf16_f32 v173, v178, v179
    v_cvt_pk_bf16_f32 v174, v180, v181
    v_cvt_pk_bf16_f32 v175, v182, v183
    v_mfma_f32_16x16x32_bf16 v[8:11], a[192:195], v[160:163], 0
    v_mfma_f32_16x16x32_bf16 v[8:11], a[196:199], v[164:167], v[8:11]
    v_mfma_f32_16x16x32_bf16 v[8:11], a[200:203], v[168:171], v[8:11]
    v_mfma_f32_16x16x32_bf16 v[8:11], a[204:207], v[172:175], v[8:11]
    v_mfma_f32_16x16x32_bf16 v[24:27], a[208:211], v[160:163], 0
    v_mfma_f32_16x16x32_bf16 v[24:27], a[212:215], v[164:167], v[24:27]
    v_accvgpr_write_b32 a160, v160
    v_mfma_f32_16x16x32_bf16 v[24:27], a[216:219], v[168:171], v[24:27]
    v_accvgpr_write_b32 a161, v161
    v_mfma_f32_16x16x32_bf16 v[24:27], a[220:223], v[172:175], v[24:27]
    v_accvgpr_write_b32 a162, v162
    v_mfma_f32_16x16x32_bf16 v[40:43], a[224:227], v[160:163], 0
    v_accvgpr_write_b32 a163, v163
    v_mfma_f32_16x16x32_bf16 v[40:43], a[228:231], v[164:167], v[40:43]
    v_accvgpr_write_b32 a164, v164
    v_mfma_f32_16x16x32_bf16 v[40:43], a[232:235], v[168:171], v[40:43]
    v_accvgpr_write_b32 a165, v165
    v_mfma_f32_16x16x32_bf16 v[40:43], a[236:239], v[172:175], v[40:43]
    v_accvgpr_write_b32 a166, v166
    v_mfma_f32_16x16x32_bf16 v[56:59], a[240:243], v[160:163], 0
    v_max3_f32 v246, v8, v9, v10
    v_accvgpr_write_b32 a167, v167
    v_mfma_f32_16x16x32_bf16 v[56:59], a[244:247], v[164:167], v[56:59]
    v_max3_f32 v246, v246, v11, v24
    v_accvgpr_write_b32 a168, v168
    v_mfma_f32_16x16x32_bf16 v[56:59], a[248:251], v[168:171], v[56:59]
    v_max3_f32 v246, v246, v25, v26
    v_accvgpr_write_b32 a169, v169
    v_mfma_f32_16x16x32_bf16 v[56:59], a[252:255], v[172:175], v[56:59]
    v_max3_f32 v246, v246, v27, v40
    v_accvgpr_write_b32 a170, v170
    v_max3_f32 v246, v246, v41, v42
    v_accvgpr_write_b32 a171, v171
    v_accvgpr_write_b32 a172, v172
    v_accvgpr_write_b32 a173, v173
    v_accvgpr_write_b32 a174, v174
    v_accvgpr_write_b32 a175, v175
    v_max3_f32 v246, v246, v43, v56
    v_max3_f32 v246, v246, v57, v58
    v_max_f32 v246, v246, v59
    v_mov_b32 v247, v246
    s_nop 1
    v_permlane32_swap_b32 v246, v247
    s_nop 1
    v_max_f32 v246, v246, v247
    v_mov_b32 v247, v246
    s_nop 1
    v_permlane16_swap_b32 v246, v247
    s_nop 1
    v_max_f32 v246, v246, v247
    v_sub_f32 v8, v8, v246
    v_sub_f32 v9, v9, v246
    v_sub_f32 v10, v10, v246
    v_sub_f32 v11, v11, v246
    v_sub_f32 v24, v24, v246
    v_sub_f32 v25, v25, v246
    v_sub_f32 v26, v26, v246
    v_sub_f32 v27, v27, v246
    v_sub_f32 v40, v40, v246
    v_sub_f32 v41, v41, v246
    v_sub_f32 v42, v42, v246
    v_sub_f32 v43, v43, v246
    v_sub_f32 v56, v56, v246
    v_sub_f32 v57, v57, v246
    v_sub_f32 v58, v58, v246
    v_sub_f32 v59, v59, v246
    v_exp_f32 v8, v8
    v_exp_f32 v9, v9
    v_exp_f32 v10, v10
    v_exp_f32 v11, v11
    v_exp_f32 v24, v24
    v_exp_f32 v25, v25
    v_exp_f32 v26, v26
    v_exp_f32 v27, v27
    v_exp_f32 v40, v40
    v_exp_f32 v41, v41
    v_exp_f32 v42, v42
    v_exp_f32 v43, v43
    v_exp_f32 v56, v56
    v_exp_f32 v57, v57
    v_exp_f32 v58, v58
    v_exp_f32 v59, v59
    v_cvt_pk_bf16_f32 v144, v8, v9
    v_cvt_pk_bf16_f32 v145, v10, v11
    v_cvt_pk_bf16_f32 v146, v24, v25
    v_cvt_pk_bf16_f32 v147, v26, v27
    v_cvt_pk_bf16_f32 v148, v40, v41
    v_cvt_pk_bf16_f32 v149, v42, v43
    v_cvt_pk_bf16_f32 v150, v56, v57
    v_cvt_pk_bf16_f32 v151, v58, v59
    v_sub_f32 v200, 0, v246
    v_sub_f32 v201, 0, v246
    v_sub_f32 v202, 0, v246
    v_sub_f32 v203, 0, v246
    v_smfmac_f32_16x16x64_bf16 v[216:219], v[236:239], v[144:151], v245
    s_waitcnt vmcnt(4)
    ds_read_b128 v[112:115], v190 offset:0
    ds_read_b128 v[116:119], v190 offset:16
    ds_read_b128 v[120:123], v190 offset:32
    ds_read_b128 v[124:127], v190 offset:48
    s_add_u32 m0, s25, 0
    s_mov_b32 s54, 0
    buffer_load_dwordx4 v244, s[16:19], s54 offen nt lds
    s_add_u32 m0, s25, 16
    s_nop 0
    buffer_load_dwordx4 v244, s[16:19], s54 offen offset:1024 nt lds
    s_add_u32 m0, s25, 32
    s_nop 0
    buffer_load_dwordx4 v244, s[16:19], s54 offen offset:2048 nt lds
    s_add_u32 m0, s25, 48
    s_nop 0
    buffer_load_dwordx4 v244, s[16:19], s54 offen offset:3072 nt lds
    s_waitcnt lgkmcnt(3)
    v_lshlrev_b32 v176, 16, v112
    v_and_b32 v177, 0xffff0000, v112
    v_lshlrev_b32 v178, 16, v113
    v_and_b32 v179, 0xffff0000, v113
    v_lshlrev_b32 v180, 16, v114
    v_and_b32 v181, 0xffff0000, v114
    v_lshlrev_b32 v182, 16, v115
    v_and_b32 v183, 0xffff0000, v115
    v_pk_mul_f32 v[176:177], v[176:177], s[34:35]
    v_pk_mul_f32 v[178:179], v[178:179], s[34:35]
    v_pk_mul_f32 v[180:181], v[180:181], s[34:35]
    v_pk_mul_f32 v[182:183], v[182:183], s[34:35]
    v_cvt_pk_bf16_f32 v160, v176, v177
    v_cvt_pk_bf16_f32 v161, v178, v179
    v_cvt_pk_bf16_f32 v162, v180, v181
    v_cvt_pk_bf16_f32 v163, v182, v183
    s_waitcnt lgkmcnt(2)
    v_lshlrev_b32 v176, 16, v116
    v_and_b32 v177, 0xffff0000, v116
    v_lshlrev_b32 v178, 16, v117
    v_and_b32 v179, 0xffff0000, v117
    v_lshlrev_b32 v180, 16, v118
    v_and_b32 v181, 0xffff0000, v118
    v_lshlrev_b32 v182, 16, v119
    v_and_b32 v183, 0xffff0000, v119
    v_pk_mul_f32 v[176:177], v[176:177], s[34:35]
    v_pk_mul_f32 v[178:179], v[178:179], s[34:35]
    v_pk_mul_f32 v[180:181], v[180:181], s[34:35]
    v_pk_mul_f32 v[182:183], v[182:183], s[34:35]
    v_cvt_pk_bf16_f32 v164, v176, v177
    v_cvt_pk_bf16_f32 v165, v178, v179
    v_cvt_pk_bf16_f32 v166, v180, v181
    v_cvt_pk_bf16_f32 v167, v182, v183
    s_waitcnt lgkmcnt(1)
    v_lshlrev_b32 v176, 16, v120
    v_and_b32 v177, 0xffff0000, v120
    v_lshlrev_b32 v178, 16, v121
    v_and_b32 v179, 0xffff0000, v121
    v_lshlrev_b32 v180, 16, v122
    v_and_b32 v181, 0xffff0000, v122
    v_lshlrev_b32 v182, 16, v123
    v_and_b32 v183, 0xffff0000, v123
    v_pk_mul_f32 v[176:177], v[176:177], s[34:35]
    v_pk_mul_f32 v[178:179], v[178:179], s[34:35]
    v_pk_mul_f32 v[180:181], v[180:181], s[34:35]
    v_pk_mul_f32 v[182:183], v[182:183], s[34:35]
    v_cvt_pk_bf16_f32 v168, v176, v177
    v_cvt_pk_bf16_f32 v169, v178, v179
    v_cvt_pk_bf16_f32 v170, v180, v181
    v_cvt_pk_bf16_f32 v171, v182, v183
    s_waitcnt lgkmcnt(0)
    v_lshlrev_b32 v176, 16, v124
    v_and_b32 v177, 0xffff0000, v124
    v_lshlrev_b32 v178, 16, v125
    v_and_b32 v179, 0xffff0000, v125
    v_lshlrev_b32 v180, 16, v126
    v_and_b32 v181, 0xffff0000, v126
    v_lshlrev_b32 v182, 16, v127
    v_and_b32 v183, 0xffff0000, v127
    v_pk_mul_f32 v[176:177], v[176:177], s[34:35]
    v_pk_mul_f32 v[178:179], v[178:179], s[34:35]
    v_pk_mul_f32 v[180:181], v[180:181], s[34:35]
    v_pk_mul_f32 v[182:183], v[182:183], s[34:35]
    v_cvt_pk_bf16_f32 v172, v176, v177
    v_cvt_pk_bf16_f32 v173, v178, v179
    v_cvt_pk_bf16_f32 v174, v180, v181
    v_cvt_pk_bf16_f32 v175, v182, v183
    v_mfma_f32_16x16x32_bf16 v[12:15], a[192:195], v[160:163], 0
    v_mfma_f32_16x16x32_bf16 v[12:15], a[196:199], v[164:167], v[12:15]
    v_mfma_f32_16x16x32_bf16 v[12:15], a[200:203], v[168:171], v[12:15]
    v_mfma_f32_16x16x32_bf16 v[12:15], a[204:207], v[172:175], v[12:15]
    v_mfma_f32_16x16x32_bf16 v[28:31], a[208:211], v[160:163], 0
    v_mfma_f32_16x16x32_bf16 v[28:31], a[212:215], v[164:167], v[28:31]
    v_accvgpr_write_b32 a176, v160
    v_mfma_f32_16x16x32_bf16 v[28:31], a[216:219], v[168:171], v[28:31]
    v_accvgpr_write_b32 a177, v161
    v_mfma_f32_16x16x32_bf16 v[28:31], a[220:223], v[172:175], v[28:31]
    v_accvgpr_write_b32 a178, v162
    v_mfma_f32_16x16x32_bf16 v[44:47], a[224:227], v[160:163], 0
    v_accvgpr_write_b32 a179, v163
    v_mfma_f32_16x16x32_bf16 v[44:47], a[228:231], v[164:167], v[44:47]
    v_accvgpr_write_b32 a180, v164
    v_mfma_f32_16x16x32_bf16 v[44:47], a[232:235], v[168:171], v[44:47]
    v_accvgpr_write_b32 a181, v165
    v_mfma_f32_16x16x32_bf16 v[44:47], a[236:239], v[172:175], v[44:47]
    v_accvgpr_write_b32 a182, v166
    v_mfma_f32_16x16x32_bf16 v[60:63], a[240:243], v[160:163], 0
    v_max3_f32 v246, v12, v13, v14
    v_accvgpr_write_b32 a183, v167
    v_mfma_f32_16x16x32_bf16 v[60:63], a[244:247], v[164:167], v[60:63]
    v_max3_f32 v246, v246, v15, v28
    v_accvgpr_write_b32 a184, v168
    v_mfma_f32_16x16x32_bf16 v[60:63], a[248:251], v[168:171], v[60:63]
    v_max3_f32 v246, v246, v29, v30
    v_accvgpr_write_b32 a185, v169
    v_mfma_f32_16x16x32_bf16 v[60:63], a[252:255], v[172:175], v[60:63]
    v_max3_f32 v246, v246, v31, v44
    v_accvgpr_write_b32 a186, v170
    v_max3_f32 v246, v246, v45, v46
    v_accvgpr_write_b32 a187, v171
    v_accvgpr_write_b32 a188, v172
    v_accvgpr_write_b32 a189, v173
    v_accvgpr_write_b32 a190, v174
    v_accvgpr_write_b32 a191, v175
    v_max3_f32 v246, v246, v47, v60
    v_max3_f32 v246, v246, v61, v62
    v_max_f32 v246, v246, v63
    v_mov_b32 v247, v246
    s_nop 1
    v_permlane32_swap_b32 v246, v247
    s_nop 1
    v_max_f32 v246, v246, v247
    v_mov_b32 v247, v246
    s_nop 1
    v_permlane16_swap_b32 v246, v247
    s_nop 1
    v_max_f32 v246, v246, v247
    v_sub_f32 v12, v12, v246
    v_sub_f32 v13, v13, v246
    v_sub_f32 v14, v14, v246
    v_sub_f32 v15, v15, v246
    v_sub_f32 v28, v28, v246
    v_sub_f32 v29, v29, v246
    v_sub_f32 v30, v30, v246
    v_sub_f32 v31, v31, v246
    v_sub_f32 v44, v44, v246
    v_sub_f32 v45, v45, v246
    v_sub_f32 v46, v46, v246
    v_sub_f32 v47, v47, v246
    v_sub_f32 v60, v60, v246
    v_sub_f32 v61, v61, v246
    v_sub_f32 v62, v62, v246
    v_sub_f32 v63, v63, v246
    v_exp_f32 v12, v12
    v_exp_f32 v13, v13
    v_exp_f32 v14, v14
    v_exp_f32 v15, v15
    v_exp_f32 v28, v28
    v_exp_f32 v29, v29
    v_exp_f32 v30, v30
    v_exp_f32 v31, v31
    v_exp_f32 v44, v44
    v_exp_f32 v45, v45
    v_exp_f32 v46, v46
    v_exp_f32 v47, v47
    v_exp_f32 v60, v60
    v_exp_f32 v61, v61
    v_exp_f32 v62, v62
    v_exp_f32 v63, v63
    v_cvt_pk_bf16_f32 v152, v12, v13
    v_cvt_pk_bf16_f32 v153, v14, v15
    v_cvt_pk_bf16_f32 v154, v28, v29
    v_cvt_pk_bf16_f32 v155, v30, v31
    v_cvt_pk_bf16_f32 v156, v44, v45
    v_cvt_pk_bf16_f32 v157, v46, v47
    v_cvt_pk_bf16_f32 v158, v60, v61
    v_cvt_pk_bf16_f32 v159, v62, v63
    v_sub_f32 v204, 0, v246
    v_sub_f32 v205, 0, v246
    v_sub_f32 v206, 0, v246
    v_sub_f32 v207, 0, v246
    v_smfmac_f32_16x16x64_bf16 v[220:223], v[236:239], v[152:159], v245
    s_waitcnt vmcnt(4)
    s_barrier
    ds_read_b128 a[192:195], v240 offset:0
    ds_read_b128 a[196:199], v240 offset:16
    ds_read_b128 a[200:203], v240 offset:32
    ds_read_b128 a[204:207], v240 offset:48
    ds_read_b128 a[208:211], v240 offset:256
    ds_read_b128 a[212:215], v240 offset:272
    ds_read_b128 a[216:219], v240 offset:288
    ds_read_b128 a[220:223], v240 offset:304
    s_waitcnt lgkmcnt(4)
    v_mfma_f32_16x16x32_bf16 v[64:67], a[192:195], a[128:131], v[192:195]
    s_mov_b32 s54, 32768
    s_add_u32 m0, s25, 16640
    v_mfma_f32_16x16x32_bf16 v[64:67], a[196:199], a[132:135], v[64:67]
    buffer_load_dwordx4 v244, s[12:15], s54 offen nt lds
    s_add_u32 m0, s25, 16656
    v_mfma_f32_16x16x32_bf16 v[64:67], a[200:203], a[136:139], v[64:67]
    v_mfma_f32_16x16x32_bf16 v[64:67], a[204:207], a[140:143], v[64:67]
    v_mfma_f32_16x16x32_bf16 v[68:71], a[204:207], a[156:159], v[196:199]
    v_mfma_f32_16x16x32_bf16 v[68:71], a[200:203], a[152:155], v[68:71]
    buffer_load_dwordx4 v244, s[12:15], s54 offen offset:1024 nt lds
    s_add_u32 m0, s25, 16672
    v_mfma_f32_16x16x32_bf16 v[68:71], a[196:199], a[148:151], v[68:71]
    v_mfma_f32_16x16x32_bf16 v[68:71], a[192:195], a[144:147], v[68:71]
    v_mfma_f32_16x16x32_bf16 v[72:75], a[192:195], a[160:163], v[200:203]
    ds_read_b128 a[224:227], v240 offset:512
    v_mfma_f32_16x16x32_bf16 v[72:75], a[196:199], a[164:167], v[72:75]
    buffer_load_dwordx4 v244, s[12:15], s54 offen offset:2048 nt lds
    s_add_u32 m0, s25, 16688
    v_mfma_f32_16x16x32_bf16 v[72:75], a[200:203], a[168:171], v[72:75]
    ds_read_b128 a[228:231], v240 offset:528
    v_mfma_f32_16x16x32_bf16 v[72:75], a[204:207], a[172:175], v[72:75]
    v_mfma_f32_16x16x32_bf16 v[76:79], a[204:207], a[188:191], v[204:207]
    ds_read_b128 a[232:235], v240 offset:544
    v_mfma_f32_16x16x32_bf16 v[76:79], a[200:203], a[184:187], v[76:79]
    buffer_load_dwordx4 v244, s[12:15], s54 offen offset:3072 nt lds
    v_mfma_f32_16x16x32_bf16 v[76:79], a[196:199], a[180:183], v[76:79]
    ds_read_b128 a[236:239], v240 offset:560
    v_mfma_f32_16x16x32_bf16 v[76:79], a[192:195], a[176:179], v[76:79]
    s_waitcnt lgkmcnt(4)
    v_mfma_f32_16x16x32_bf16 v[92:95], a[208:211], a[176:179], v[204:207]
    v_mfma_f32_16x16x32_bf16 v[92:95], a[212:215], a[180:183], v[92:95]
    v_mfma_f32_16x16x32_bf16 v[92:95], a[216:219], a[184:187], v[92:95]
    v_mfma_f32_16x16x32_bf16 v[92:95], a[220:223], a[188:191], v[92:95]
    v_mfma_f32_16x16x32_bf16 v[88:91], a[220:223], a[172:175], v[200:203]
    v_add_f32 v224, v208, v209
    v_mfma_f32_16x16x32_bf16 v[88:91], a[216:219], a[168:171], v[88:91]
    v_add_f32 v225, v212, v213
    v_mfma_f32_16x16x32_bf16 v[88:91], a[212:215], a[164:167], v[88:91]
    v_add_f32 v226, v216, v217
    v_mfma_f32_16x16x32_bf16 v[88:91], a[208:211], a[160:163], v[88:91]
    v_add_f32 v227, v220, v221
    v_mfma_f32_16x16x32_bf16 v[84:87], a[208:211], a[144:147], v[196:199]
    ds_read_b128 a[240:243], v240 offset:768
    v_mfma_f32_16x16x32_bf16 v[84:87], a[212:215], a[148:151], v[84:87]
    v_mfma_f32_16x16x32_bf16 v[84:87], a[216:219], a[152:155], v[84:87]
    ds_read_b128 a[244:247], v240 offset:784
    v_mfma_f32_16x16x32_bf16 v[84:87], a[220:223], a[156:159], v[84:87]
    v_mfma_f32_16x16x32_bf16 v[80:83], a[220:223], a[140:143], v[192:195]
    ds_read_b128 a[248:251], v240 offset:800
    v_mfma_f32_16x16x32_bf16 v[80:83], a[216:219], a[136:139], v[80:83]
    v_mfma_f32_16x16x32_bf16 v[80:83], a[212:215], a[132:135], v[80:83]
    ds_read_b128 a[252:255], v240 offset:816
    v_mfma_f32_16x16x32_bf16 v[80:83], a[208:211], a[128:131], v[80:83]
    s_waitcnt lgkmcnt(4)
    v_mfma_f32_16x16x32_bf16 v[96:99], a[224:227], a[128:131], v[192:195]
    v_mfma_f32_16x16x32_bf16 v[96:99], a[228:231], a[132:135], v[96:99]
    v_mfma_f32_16x16x32_bf16 v[96:99], a[232:235], a[136:139], v[96:99]
    v_mfma_f32_16x16x32_bf16 v[96:99], a[236:239], a[140:143], v[96:99]
    v_mfma_f32_16x16x32_bf16 v[100:103], a[236:239], a[156:159], v[196:199]
    v_mfma_f32_16x16x32_bf16 v[100:103], a[232:235], a[152:155], v[100:103]
    v_mfma_f32_16x16x32_bf16 v[100:103], a[228:231], a[148:151], v[100:103]
    v_mfma_f32_16x16x32_bf16 v[100:103], a[224:227], a[144:147], v[100:103]
    v_mfma_f32_16x16x32_bf16 v[104:107], a[224:227], a[160:163], v[200:203]
    v_mfma_f32_16x16x32_bf16 v[104:107], a[228:231], a[164:167], v[104:107]
    v_mfma_f32_16x16x32_bf16 v[104:107], a[232:235], a[168:171], v[104:107]
    v_mfma_f32_16x16x32_bf16 v[104:107], a[236:239], a[172:175], v[104:107]
    v_mfma_f32_16x16x32_bf16 v[108:111], a[236:239], a[188:191], v[204:207]
    v_mfma_f32_16x16x32_bf16 v[108:111], a[232:235], a[184:187], v[108:111]
    v_mfma_f32_16x16x32_bf16 v[108:111], a[228:231], a[180:183], v[108:111]
    v_mfma_f32_16x16x32_bf16 v[108:111], a[224:227], a[176:179], v[108:111]
    s_waitcnt lgkmcnt(0)
    v_mfma_f32_16x16x32_bf16 v[124:127], a[240:243], a[176:179], v[204:207]
    v_mfma_f32_16x16x32_bf16 v[124:127], a[244:247], a[180:183], v[124:127]
    v_mfma_f32_16x16x32_bf16 v[124:127], a[248:251], a[184:187], v[124:127]
    v_mfma_f32_16x16x32_bf16 v[124:127], a[252:255], a[188:191], v[124:127]
    s_mov_b32 s54, 16384
    s_add_u32 m0, s25, 33280
    v_mfma_f32_16x16x32_bf16 v[120:123], a[252:255], a[172:175], v[200:203]
    buffer_load_dwordx4 v244, s[16:19], s54 offen nt lds
    s_add_u32 m0, s25, 33296
    v_mfma_f32_16x16x32_bf16 v[120:123], a[248:251], a[168:171], v[120:123]
    v_mfma_f32_16x16x32_bf16 v[120:123], a[244:247], a[164:167], v[120:123]
    v_mfma_f32_16x16x32_bf16 v[120:123], a[240:243], a[160:163], v[120:123]
    v_mfma_f32_16x16x32_bf16 v[116:119], a[240:243], a[144:147], v[196:199]
    buffer_load_dwordx4 v244, s[16:19], s54 offen offset:1024 nt lds
    s_add_u32 m0, s25, 33312
    v_mfma_f32_16x16x32_bf16 v[116:119], a[244:247], a[148:151], v[116:119]
    v_mfma_f32_16x16x32_bf16 v[116:119], a[248:251], a[152:155], v[116:119]
    v_mfma_f32_16x16x32_bf16 v[116:119], a[252:255], a[156:159], v[116:119]
    v_mfma_f32_16x16x32_bf16 v[112:115], a[252:255], a[140:143], v[192:195]
    buffer_load_dwordx4 v244, s[16:19], s54 offen offset:2048 nt lds
    s_add_u32 m0, s25, 33328
    v_mfma_f32_16x16x32_bf16 v[112:115], a[248:251], a[136:139], v[112:115]
    v_mfma_f32_16x16x32_bf16 v[112:115], a[244:247], a[132:135], v[112:115]
    v_mfma_f32_16x16x32_bf16 v[112:115], a[240:243], a[128:131], v[112:115]
    s_nop 1
    v_exp_f32 v228, v64
    v_exp_f32 v229, v65
    v_exp_f32 v230, v66
    v_exp_f32 v231, v67
    v_exp_f32 v232, v80
    v_exp_f32 v233, v81
    v_exp_f32 v234, v82
    v_exp_f32 v235, v83
    buffer_load_dwordx4 v244, s[16:19], s54 offen offset:3072 nt lds
    v_cvt_pk_bf16_f32 v160, v228, v229
    v_cvt_pk_bf16_f32 v161, v230, v231
    v_cvt_pk_bf16_f32 v162, v232, v233
    v_cvt_pk_bf16_f32 v163, v234, v235
    v_exp_f32 v228, v96
    v_exp_f32 v229, v97
    v_exp_f32 v230, v98
    v_exp_f32 v231, v99
    v_exp_f32 v232, v112
    v_exp_f32 v233, v113
    v_exp_f32 v234, v114
    v_exp_f32 v235, v115
    s_nop 0
    v_cvt_pk_bf16_f32 v164, v228, v229
    v_cvt_pk_bf16_f32 v165, v230, v231
    v_cvt_pk_bf16_f32 v166, v232, v233
    v_cvt_pk_bf16_f32 v167, v234, v235
    v_exp_f32 v228, v68
    v_exp_f32 v229, v69
    v_exp_f32 v230, v70
    v_exp_f32 v231, v71
    v_exp_f32 v232, v84
    v_exp_f32 v233, v85
    v_exp_f32 v234, v86
    v_exp_f32 v235, v87
    s_nop 0
    v_smfmac_f32_16x16x64_bf16 v[208:211], v[236:239], v[160:167], v245
    v_cvt_pk_bf16_f32 v168, v228, v229
    v_cvt_pk_bf16_f32 v169, v230, v231
    v_cvt_pk_bf16_f32 v170, v232, v233
    v_cvt_pk_bf16_f32 v171, v234, v235
    v_exp_f32 v228, v100
    v_exp_f32 v229, v101
    v_exp_f32 v230, v102
    v_exp_f32 v231, v103
    v_exp_f32 v232, v116
    v_exp_f32 v233, v117
    v_exp_f32 v234, v118
    v_exp_f32 v235, v119
    s_nop 0
    v_cvt_pk_bf16_f32 v172, v228, v229
    v_cvt_pk_bf16_f32 v173, v230, v231
    v_cvt_pk_bf16_f32 v174, v232, v233
    v_cvt_pk_bf16_f32 v175, v234, v235
    v_exp_f32 v228, v72
    v_exp_f32 v229, v73
    v_exp_f32 v230, v74
    v_exp_f32 v231, v75
    v_exp_f32 v232, v88
    v_exp_f32 v233, v89
    v_exp_f32 v234, v90
    v_exp_f32 v235, v91
    s_nop 0
    v_smfmac_f32_16x16x64_bf16 v[212:215], v[236:239], v[168:175], v245
    v_cvt_pk_bf16_f32 v176, v228, v229
    v_cvt_pk_bf16_f32 v177, v230, v231
    v_cvt_pk_bf16_f32 v178, v232, v233
    v_cvt_pk_bf16_f32 v179, v234, v235
    v_exp_f32 v228, v104
    v_exp_f32 v229, v105
    v_exp_f32 v230, v106
    v_exp_f32 v231, v107
    v_exp_f32 v232, v120
    v_exp_f32 v233, v121
    v_exp_f32 v234, v122
    v_exp_f32 v235, v123
    s_nop 0
    v_cvt_pk_bf16_f32 v180, v228, v229
    v_cvt_pk_bf16_f32 v181, v230, v231
    v_cvt_pk_bf16_f32 v182, v232, v233
    v_cvt_pk_bf16_f32 v183, v234, v235
    s_waitcnt vmcnt(8) lgkmcnt(0)
    s_barrier
    ds_read_b64_tr_b16 a[192:193], v241 offset:0
    ds_read_b64_tr_b16 a[194:195], v241 offset:256
    ds_read_b64_tr_b16 a[196:197], v241 offset:512
    ds_read_b64_tr_b16 a[198:199], v241 offset:768
    ds_read_b64_tr_b16 a[200:201], v241 offset:32
    ds_read_b64_tr_b16 a[202:203], v241 offset:288
    ds_read_b64_tr_b16 a[204:205], v241 offset:544
    ds_read_b64_tr_b16 a[206:207], v241 offset:800
    ds_read_b64_tr_b16 a[208:209], v241 offset:64
    ds_read_b64_tr_b16 a[210:211], v241 offset:320
    ds_read_b64_tr_b16 a[212:213], v241 offset:576
    ds_read_b64_tr_b16 a[214:215], v241 offset:832
    ds_read_b64_tr_b16 a[216:217], v241 offset:96
    ds_read_b64_tr_b16 a[218:219], v241 offset:352
    ds_read_b64_tr_b16 a[220:221], v241 offset:608
    ds_read_b64_tr_b16 a[222:223], v241 offset:864
    v_exp_f32 v228, v76
    v_exp_f32 v229, v77
    v_exp_f32 v230, v78
    v_exp_f32 v231, v79
    v_exp_f32 v232, v92
    v_exp_f32 v233, v93
    v_exp_f32 v234, v94
    v_exp_f32 v235, v95
    s_nop 0
    v_smfmac_f32_16x16x64_bf16 v[216:219], v[236:239], v[176:183], v245
    v_cvt_pk_bf16_f32 v184, v228, v229
    v_cvt_pk_bf16_f32 v185, v230, v231
    v_cvt_pk_bf16_f32 v186, v232, v233
    v_cvt_pk_bf16_f32 v187, v234, v235
    v_exp_f32 v228, v108
    v_exp_f32 v229, v109
    v_exp_f32 v230, v110
    v_exp_f32 v231, v111
    v_exp_f32 v232, v124
    v_exp_f32 v233, v125
    v_exp_f32 v234, v126
    v_exp_f32 v235, v127
    s_nop 0
    v_cvt_pk_bf16_f32 v188, v228, v229
    v_cvt_pk_bf16_f32 v189, v230, v231
    v_cvt_pk_bf16_f32 v190, v232, v233
    v_cvt_pk_bf16_f32 v191, v234, v235
    v_add_f32 v248, v208, v209
    v_add_f32 v249, v212, v213
    v_smfmac_f32_16x16x64_bf16 v[220:223], v[236:239], v[184:191], v245
    s_waitcnt lgkmcnt(8)
    v_mfma_f32_16x16x32_bf16 a[0:3], a[192:195], v[128:131], a[0:3]
    v_mfma_f32_16x16x32_bf16 a[0:3], a[196:199], v[132:135], a[0:3]
    v_mfma_f32_16x16x32_bf16 a[32:35], a[196:199], v[140:143], a[32:35]
    v_add_u32 v240, 16640, v242
    v_mfma_f32_16x16x32_bf16 a[32:35], a[192:195], v[136:139], a[32:35]
    v_mfma_f32_16x16x32_bf16 a[64:67], a[192:195], v[144:147], a[64:67]
    v_mfma_f32_16x16x32_bf16 a[64:67], a[196:199], v[148:151], a[64:67]
    v_mfma_f32_16x16x32_bf16 a[96:99], a[196:199], v[156:159], a[96:99]
    v_mfma_f32_16x16x32_bf16 a[96:99], a[192:195], v[152:155], a[96:99]
    v_mfma_f32_16x16x32_bf16 a[100:103], a[200:203], v[152:155], a[100:103]
    ds_read_b64_tr_b16 a[224:225], v241 offset:128
    ds_read_b64_tr_b16 a[226:227], v241 offset:384
    v_mfma_f32_16x16x32_bf16 a[100:103], a[204:207], v[156:159], a[100:103]
    v_mfma_f32_16x16x32_bf16 a[68:71], a[204:207], v[148:151], a[68:71]
    ds_read_b64_tr_b16 a[228:229], v241 offset:640
    ds_read_b64_tr_b16 a[230:231], v241 offset:896
    v_mfma_f32_16x16x32_bf16 a[68:71], a[200:203], v[144:147], a[68:71]
    v_mfma_f32_16x16x32_bf16 a[36:39], a[200:203], v[136:139], a[36:39]
    ds_read_b64_tr_b16 a[232:233], v241 offset:160
    ds_read_b64_tr_b16 a[234:235], v241 offset:416
    v_mfma_f32_16x16x32_bf16 a[36:39], a[204:207], v[140:143], a[36:39]
    v_mfma_f32_16x16x32_bf16 a[4:7], a[204:207], v[132:135], a[4:7]
    ds_read_b64_tr_b16 a[236:237], v241 offset:672
    ds_read_b64_tr_b16 a[238:239], v241 offset:928
    v_add_f32 v250, v216, v217
    v_mfma_f32_16x16x32_bf16 a[4:7], a[200:203], v[128:131], a[4:7]
    v_max3_f32 v246, v248, v249, v250
    s_waitcnt lgkmcnt(8)
    v_mfma_f32_16x16x32_bf16 a[8:11], a[208:211], v[128:131], a[8:11]
    v_add_f32 v251, v220, v221
    v_mfma_f32_16x16x32_bf16 a[8:11], a[212:215], v[132:135], a[8:11]
    v_max_f32 v246, v246, v251
    v_mfma_f32_16x16x32_bf16 a[40:43], a[212:215], v[140:143], a[40:43]
    v_cmp_nge_f32 vcc, s28, v246
    v_mfma_f32_16x16x32_bf16 a[40:43], a[208:211], v[136:139], a[40:43]
    v_mfma_f32_16x16x32_bf16 a[72:75], a[208:211], v[144:147], a[72:75]
    v_mfma_f32_16x16x32_bf16 a[72:75], a[212:215], v[148:151], a[72:75]
    v_mfma_f32_16x16x32_bf16 a[104:107], a[212:215], v[156:159], a[104:107]
    v_mfma_f32_16x16x32_bf16 a[104:107], a[208:211], v[152:155], a[104:107]
    v_mfma_f32_16x16x32_bf16 a[108:111], a[216:219], v[152:155], a[108:111]
    ds_read_b64_tr_b16 a[240:241], v241 offset:192
    ds_read_b64_tr_b16 a[242:243], v241 offset:448
    v_mfma_f32_16x16x32_bf16 a[108:111], a[220:223], v[156:159], a[108:111]
    v_mfma_f32_16x16x32_bf16 a[76:79], a[220:223], v[148:151], a[76:79]
    ds_read_b64_tr_b16 a[244:245], v241 offset:704
    ds_read_b64_tr_b16 a[246:247], v241 offset:960
    v_mfma_f32_16x16x32_bf16 a[76:79], a[216:219], v[144:147], a[76:79]
    v_mfma_f32_16x16x32_bf16 a[44:47], a[216:219], v[136:139], a[44:47]
    ds_read_b64_tr_b16 a[248:249], v241 offset:224
    ds_read_b64_tr_b16 a[250:251], v241 offset:480
    v_mfma_f32_16x16x32_bf16 a[44:47], a[220:223], v[140:143], a[44:47]
    v_mfma_f32_16x16x32_bf16 a[12:15], a[220:223], v[132:135], a[12:15]
    ds_read_b64_tr_b16 a[252:253], v241 offset:736
    ds_read_b64_tr_b16 a[254:255], v241 offset:992
    v_mfma_f32_16x16x32_bf16 a[12:15], a[216:219], v[128:131], a[12:15]
    s_waitcnt lgkmcnt(8)
    v_mfma_f32_16x16x32_bf16 a[16:19], a[224:227], v[128:131], a[16:19]
    v_mfma_f32_16x16x32_bf16 a[16:19], a[228:231], v[132:135], a[16:19]
    v_mfma_f32_16x16x32_bf16 a[48:51], a[228:231], v[140:143], a[48:51]
    v_mfma_f32_16x16x32_bf16 a[48:51], a[224:227], v[136:139], a[48:51]
    v_mfma_f32_16x16x32_bf16 a[80:83], a[224:227], v[144:147], a[80:83]
    v_mfma_f32_16x16x32_bf16 a[80:83], a[228:231], v[148:151], a[80:83]
    v_mfma_f32_16x16x32_bf16 a[112:115], a[228:231], v[156:159], a[112:115]
    v_mfma_f32_16x16x32_bf16 a[112:115], a[224:227], v[152:155], a[112:115]
    v_mfma_f32_16x16x32_bf16 a[116:119], a[232:235], v[152:155], a[116:119]
    v_mfma_f32_16x16x32_bf16 a[116:119], a[236:239], v[156:159], a[116:119]
    v_mfma_f32_16x16x32_bf16 a[84:87], a[236:239], v[148:151], a[84:87]
    v_mfma_f32_16x16x32_bf16 a[84:87], a[232:235], v[144:147], a[84:87]
    v_mfma_f32_16x16x32_bf16 a[52:55], a[232:235], v[136:139], a[52:55]
    v_mfma_f32_16x16x32_bf16 a[52:55], a[236:239], v[140:143], a[52:55]
    v_mfma_f32_16x16x32_bf16 a[20:23], a[236:239], v[132:135], a[20:23]
    v_mfma_f32_16x16x32_bf16 a[20:23], a[232:235], v[128:131], a[20:23]
    s_waitcnt lgkmcnt(0)
    v_mfma_f32_16x16x32_bf16 a[24:27], a[240:243], v[128:131], a[24:27]
    v_mfma_f32_16x16x32_bf16 a[24:27], a[244:247], v[132:135], a[24:27]
    v_mfma_f32_16x16x32_bf16 a[56:59], a[244:247], v[140:143], a[56:59]
    s_waitcnt vmcnt(4) lgkmcnt(0)
    s_barrier
    v_mfma_f32_16x16x32_bf16 a[56:59], a[240:243], v[136:139], a[56:59]
    ds_read_b128 a[192:195], v240 offset:0
    ds_read_b128 a[196:199], v240 offset:16
    s_mov_b32 s54, 49152
    s_add_u32 m0, s25, 49920
    v_mfma_f32_16x16x32_bf16 a[88:91], a[240:243], v[144:147], a[88:91]
    ds_read_b128 a[200:203], v240 offset:32
    ds_read_b128 a[204:207], v240 offset:48
    buffer_load_dwordx4 v244, s[12:15], s54 offen nt lds
    s_add_u32 m0, s25, 49936
    v_mfma_f32_16x16x32_bf16 a[88:91], a[244:247], v[148:151], a[88:91]
    v_mfma_f32_16x16x32_bf16 a[120:123], a[244:247], v[156:159], a[120:123]
    v_mfma_f32_16x16x32_bf16 a[120:123], a[240:243], v[152:155], a[120:123]
    v_mfma_f32_16x16x32_bf16 a[124:127], a[248:251], v[152:155], a[124:127]
    ds_read_b128 a[208:211], v240 offset:256
    buffer_load_dwordx4 v244, s[12:15], s54 offen offset:1024 nt lds
    s_add_u32 m0, s25, 49952
    v_mfma_f32_16x16x32_bf16 a[124:127], a[252:255], v[156:159], a[124:127]
    v_mfma_f32_16x16x32_bf16 a[92:95], a[252:255], v[148:151], a[92:95]
    ds_read_b128 a[212:215], v240 offset:272
    v_mfma_f32_16x16x32_bf16 a[92:95], a[248:251], v[144:147], a[92:95]
    v_mfma_f32_16x16x32_bf16 a[60:63], a[248:251], v[136:139], a[60:63]
    ds_read_b128 a[216:219], v240 offset:288
    buffer_load_dwordx4 v244, s[12:15], s54 offen offset:2048 nt lds
    s_add_u32 m0, s25, 49968
    v_mfma_f32_16x16x32_bf16 a[60:63], a[252:255], v[140:143], a[60:63]
    v_mfma_f32_16x16x32_bf16 a[28:31], a[252:255], v[132:135], a[28:31]
    ds_read_b128 a[220:223], v240 offset:304
    v_mfma_f32_16x16x32_bf16 a[28:31], a[248:251], v[128:131], a[28:31]
    s_waitcnt lgkmcnt(4)
    v_mfma_f32_16x16x32_bf16 v[0:3], a[192:195], a[128:131], v[192:195]
    buffer_load_dwordx4 v244, s[12:15], s54 offen offset:3072 nt lds
    v_mfma_f32_16x16x32_bf16 v[0:3], a[196:199], a[132:135], v[0:3]
    v_mfma_f32_16x16x32_bf16 v[0:3], a[200:203], a[136:139], v[0:3]
    v_add_u32 v241, 33280, v243
    v_mfma_f32_16x16x32_bf16 v[0:3], a[204:207], a[140:143], v[0:3]
    v_mfma_f32_16x16x32_bf16 v[4:7], a[204:207], a[156:159], v[196:199]
    v_mfma_f32_16x16x32_bf16 v[4:7], a[200:203], a[152:155], v[4:7]
    v_mfma_f32_16x16x32_bf16 v[4:7], a[196:199], a[148:151], v[4:7]
    v_mfma_f32_16x16x32_bf16 v[4:7], a[192:195], a[144:147], v[4:7]
    v_mfma_f32_16x16x32_bf16 v[8:11], a[192:195], a[160:163], v[200:203]
    ds_read_b128 a[224:227], v240 offset:512
    v_mfma_f32_16x16x32_bf16 v[8:11], a[196:199], a[164:167], v[8:11]
    v_mfma_f32_16x16x32_bf16 v[8:11], a[200:203], a[168:171], v[8:11]
    ds_read_b128 a[228:231], v240 offset:528
    v_mfma_f32_16x16x32_bf16 v[8:11], a[204:207], a[172:175], v[8:11]
    v_mfma_f32_16x16x32_bf16 v[12:15], a[204:207], a[188:191], v[204:207]
    ds_read_b128 a[232:235], v240 offset:544
    v_mfma_f32_16x16x32_bf16 v[12:15], a[200:203], a[184:187], v[12:15]
    v_mfma_f32_16x16x32_bf16 v[12:15], a[196:199], a[180:183], v[12:15]
    ds_read_b128 a[236:239], v240 offset:560
    v_mfma_f32_16x16x32_bf16 v[12:15], a[192:195], a[176:179], v[12:15]
    s_waitcnt lgkmcnt(4)
    v_mfma_f32_16x16x32_bf16 v[28:31], a[208:211], a[176:179], v[204:207]
    v_mfma_f32_16x16x32_bf16 v[28:31], a[212:215], a[180:183], v[28:31]
    v_mfma_f32_16x16x32_bf16 v[28:31], a[216:219], a[184:187], v[28:31]
    v_mfma_f32_16x16x32_bf16 v[28:31], a[220:223], a[188:191], v[28:31]
    v_mfma_f32_16x16x32_bf16 v[24:27], a[220:223], a[172:175], v[200:203]
    v_mfma_f32_16x16x32_bf16 v[24:27], a[216:219], a[168:171], v[24:27]
    v_mfma_f32_16x16x32_bf16 v[24:27], a[212:215], a[164:167], v[24:27]
    v_mfma_f32_16x16x32_bf16 v[24:27], a[208:211], a[160:163], v[24:27]
    v_mfma_f32_16x16x32_bf16 v[20:23], a[208:211], a[144:147], v[196:199]
    ds_read_b128 a[240:243], v240 offset:768
    v_mfma_f32_16x16x32_bf16 v[20:23], a[212:215], a[148:151], v[20:23]
    v_mfma_f32_16x16x32_bf16 v[20:23], a[216:219], a[152:155], v[20:23]
    ds_read_b128 a[244:247], v240 offset:784
    v_mfma_f32_16x16x32_bf16 v[20:23], a[220:223], a[156:159], v[20:23]
    v_mfma_f32_16x16x32_bf16 v[16:19], a[220:223], a[140:143], v[192:195]
    ds_read_b128 a[248:251], v240 offset:800
    v_mfma_f32_16x16x32_bf16 v[16:19], a[216:219], a[136:139], v[16:19]
    v_mfma_f32_16x16x32_bf16 v[16:19], a[212:215], a[132:135], v[16:19]
    ds_read_b128 a[252:255], v240 offset:816
    v_mfma_f32_16x16x32_bf16 v[16:19], a[208:211], a[128:131], v[16:19]
    s_waitcnt lgkmcnt(4)
    v_mfma_f32_16x16x32_bf16 v[32:35], a[224:227], a[128:131], v[192:195]
    v_mfma_f32_16x16x32_bf16 v[32:35], a[228:231], a[132:135], v[32:35]
    v_mfma_f32_16x16x32_bf16 v[32:35], a[232:235], a[136:139], v[32:35]
    v_mfma_f32_16x16x32_bf16 v[32:35], a[236:239], a[140:143], v[32:35]
    v_mfma_f32_16x16x32_bf16 v[36:39], a[236:239], a[156:159], v[196:199]
    v_mfma_f32_16x16x32_bf16 v[36:39], a[232:235], a[152:155], v[36:39]
    v_mfma_f32_16x16x32_bf16 v[36:39], a[228:231], a[148:151], v[36:39]
    v_mfma_f32_16x16x32_bf16 v[36:39], a[224:227], a[144:147], v[36:39]
    v_mfma_f32_16x16x32_bf16 v[40:43], a[224:227], a[160:163], v[200:203]
    v_mfma_f32_16x16x32_bf16 v[40:43], a[228:231], a[164:167], v[40:43]
    v_mfma_f32_16x16x32_bf16 v[40:43], a[232:235], a[168:171], v[40:43]
    v_mfma_f32_16x16x32_bf16 v[40:43], a[236:239], a[172:175], v[40:43]
    v_mfma_f32_16x16x32_bf16 v[44:47], a[236:239], a[188:191], v[204:207]
    v_mfma_f32_16x16x32_bf16 v[44:47], a[232:235], a[184:187], v[44:47]
    v_mfma_f32_16x16x32_bf16 v[44:47], a[228:231], a[180:183], v[44:47]
    v_mfma_f32_16x16x32_bf16 v[44:47], a[224:227], a[176:179], v[44:47]
    s_waitcnt lgkmcnt(0)
    v_mfma_f32_16x16x32_bf16 v[60:63], a[240:243], a[176:179], v[204:207]
    v_mfma_f32_16x16x32_bf16 v[60:63], a[244:247], a[180:183], v[60:63]
    v_mfma_f32_16x16x32_bf16 v[60:63], a[248:251], a[184:187], v[60:63]
    s_waitcnt vmcnt(4) lgkmcnt(0)
    s_barrier
    v_mfma_f32_16x16x32_bf16 v[60:63], a[252:255], a[188:191], v[60:63]
    ds_read_b64_tr_b16 a[192:193], v241 offset:0
    ds_read_b64_tr_b16 a[194:195], v241 offset:256
    s_mov_b32 s54, 32768
    s_add_u32 m0, s25, 66560
    v_mfma_f32_16x16x32_bf16 v[56:59], a[252:255], a[172:175], v[200:203]
    ds_read_b64_tr_b16 a[196:197], v241 offset:512
    ds_read_b64_tr_b16 a[198:199], v241 offset:768
    buffer_load_dwordx4 v244, s[16:19], s54 offen nt lds
    s_add_u32 m0, s25, 66576
    v_mfma_f32_16x16x32_bf16 v[56:59], a[248:251], a[168:171], v[56:59]
    ds_read_b64_tr_b16 a[200:201], v241 offset:32
    ds_read_b64_tr_b16 a[202:203], v241 offset:288
    v_mfma_f32_16x16x32_bf16 v[56:59], a[244:247], a[164:167], v[56:59]
    ds_read_b64_tr_b16 a[204:205], v241 offset:544
    ds_read_b64_tr_b16 a[206:207], v241 offset:800
    v_mfma_f32_16x16x32_bf16 v[56:59], a[240:243], a[160:163], v[56:59]
    v_mfma_f32_16x16x32_bf16 v[52:55], a[240:243], a[144:147], v[196:199]
    ds_read_b64_tr_b16 a[208:209], v241 offset:64
    ds_read_b64_tr_b16 a[210:211], v241 offset:320
    buffer_load_dwordx4 v244, s[16:19], s54 offen offset:1024 nt lds
    s_add_u32 m0, s25, 66592
    v_mfma_f32_16x16x32_bf16 v[52:55], a[244:247], a[148:151], v[52:55]
    v_mfma_f32_16x16x32_bf16 v[52:55], a[248:251], a[152:155], v[52:55]
    ds_read_b64_tr_b16 a[212:213], v241 offset:576
    ds_read_b64_tr_b16 a[214:215], v241 offset:832
    v_mfma_f32_16x16x32_bf16 v[52:55], a[252:255], a[156:159], v[52:55]
    v_mfma_f32_16x16x32_bf16 v[48:51], a[252:255], a[140:143], v[192:195]
    ds_read_b64_tr_b16 a[216:217], v241 offset:96
    ds_read_b64_tr_b16 a[218:219], v241 offset:352
    buffer_load_dwordx4 v244, s[16:19], s54 offen offset:2048 nt lds
    s_add_u32 m0, s25, 66608
    v_mfma_f32_16x16x32_bf16 v[48:51], a[248:251], a[136:139], v[48:51]
    v_mfma_f32_16x16x32_bf16 v[48:51], a[244:247], a[132:135], v[48:51]
    ds_read_b64_tr_b16 a[220:221], v241 offset:608
    ds_read_b64_tr_b16 a[222:223], v241 offset:864
    v_mfma_f32_16x16x32_bf16 v[48:51], a[240:243], a[128:131], v[48:51]
    s_cbranch_vccnz L_fb_r1
L_r1:
    s_waitcnt lgkmcnt(8)
    v_mfma_f32_16x16x32_bf16 a[0:3], a[192:195], v[160:163], a[0:3]
    buffer_load_dwordx4 v244, s[16:19], s54 offen offset:3072 nt lds
    v_exp_f32 v228, v0
    v_exp_f32 v229, v1
    v_mfma_f32_16x16x32_bf16 a[0:3], a[196:199], v[164:167], a[0:3]
    v_cvt_pk_bf16_f32 v128, v228, v229
    v_exp_f32 v230, v2
    v_mfma_f32_16x16x32_bf16 a[32:35], a[196:199], v[172:175], a[32:35]
    v_exp_f32 v231, v3
    v_mfma_f32_16x16x32_bf16 a[32:35], a[192:195], v[168:171], a[32:35]
    v_cvt_pk_bf16_f32 v129, v230, v231
    v_exp_f32 v232, v16
    v_mfma_f32_16x16x32_bf16 a[64:67], a[192:195], v[176:179], a[64:67]
    s_mov_b32 s54, 65536
    s_add_u32 m0, s25, 83200
    v_exp_f32 v233, v17
    v_mfma_f32_16x16x32_bf16 a[64:67], a[196:199], v[180:183], a[64:67]
    buffer_load_dwordx4 v244, s[12:15], s54 offen nt lds
    s_add_u32 m0, s25, 83216
    v_cvt_pk_bf16_f32 v130, v232, v233
    v_exp_f32 v234, v18
    v_exp_f32 v235, v19
    v_mfma_f32_16x16x32_bf16 a[96:99], a[196:199], v[188:191], a[96:99]
    v_cvt_pk_bf16_f32 v131, v234, v235
    v_exp_f32 v228, v32
    v_mfma_f32_16x16x32_bf16 a[96:99], a[192:195], v[184:187], a[96:99]
    v_exp_f32 v229, v33
    v_mfma_f32_16x16x32_bf16 a[100:103], a[200:203], v[184:187], a[100:103]
    ds_read_b64_tr_b16 a[224:225], v241 offset:128
    ds_read_b64_tr_b16 a[226:227], v241 offset:384
    v_cvt_pk_bf16_f32 v132, v228, v229
    v_exp_f32 v230, v34
    v_mfma_f32_16x16x32_bf16 a[100:103], a[204:207], v[188:191], a[100:103]
    buffer_load_dwordx4 v244, s[12:15], s54 offen offset:1024 nt lds
    s_add_u32 m0, s25, 83232
    v_exp_f32 v231, v35
    v_mfma_f32_16x16x32_bf16 a[68:71], a[204:207], v[180:183], a[68:71]
    ds_read_b64_tr_b16 a[228:229], v241 offset:640
    ds_read_b64_tr_b16 a[230:231], v241 offset:896
    v_cvt_pk_bf16_f32 v133, v230, v231
    v_exp_f32 v232, v48
    v_exp_f32 v233, v49
    v_mfma_f32_16x16x32_bf16 a[68:71], a[200:203], v[176:179], a[68:71]
    v_cvt_pk_bf16_f32 v134, v232, v233
    v_exp_f32 v234, v50
    v_mfma_f32_16x16x32_bf16 a[36:39], a[200:203], v[168:171], a[36:39]
    ds_read_b64_tr_b16 a[232:233], v241 offset:160
    ds_read_b64_tr_b16 a[234:235], v241 offset:416
    v_exp_f32 v235, v51
    v_mfma_f32_16x16x32_bf16 a[36:39], a[204:207], v[172:175], a[36:39]
    buffer_load_dwordx4 v244, s[12:15], s54 offen offset:2048 nt lds
    s_add_u32 m0, s25, 83248
    v_cvt_pk_bf16_f32 v135, v234, v235
    v_exp_f32 v228, v4
    v_mfma_f32_16x16x32_bf16 a[4:7], a[204:207], v[164:167], a[4:7]
    ds_read_b64_tr_b16 a[236:237], v241 offset:672
    ds_read_b64_tr_b16 a[238:239], v241 offset:928
    v_exp_f32 v229, v5
    v_mfma_f32_16x16x32_bf16 a[4:7], a[200:203], v[160:163], a[4:7]
    v_cvt_pk_bf16_f32 v136, v228, v229
    v_exp_f32 v230, v6
    v_smfmac_f32_16x16x64_bf16 v[208:211], v[236:239], v[128:135], v245
    s_waitcnt lgkmcnt(8)
    v_mfma_f32_16x16x32_bf16 a[8:11], a[208:211], v[160:163], a[8:11]
    v_exp_f32 v231, v7
    v_exp_f32 v232, v20
    v_mfma_f32_16x16x32_bf16 a[8:11], a[212:215], v[164:167], a[8:11]
    buffer_load_dwordx4 v244, s[12:15], s54 offen offset:3072 nt lds
    v_cvt_pk_bf16_f32 v137, v230, v231
    v_exp_f32 v233, v21
    v_mfma_f32_16x16x32_bf16 a[40:43], a[212:215], v[172:175], a[40:43]
    v_add_u32 v240, 49920, v242
    v_cvt_pk_bf16_f32 v138, v232, v233
    v_exp_f32 v234, v22
    v_mfma_f32_16x16x32_bf16 a[40:43], a[208:211], v[168:171], a[40:43]
    v_exp_f32 v235, v23
    v_mfma_f32_16x16x32_bf16 a[72:75], a[208:211], v[176:179], a[72:75]
    v_cvt_pk_bf16_f32 v139, v234, v235
    v_exp_f32 v228, v36
    v_mfma_f32_16x16x32_bf16 a[72:75], a[212:215], v[180:183], a[72:75]
    v_exp_f32 v229, v37
    v_exp_f32 v230, v38
    v_mfma_f32_16x16x32_bf16 a[104:107], a[212:215], v[188:191], a[104:107]
    v_cvt_pk_bf16_f32 v140, v228, v229
    v_exp_f32 v231, v39
    v_mfma_f32_16x16x32_bf16 a[104:107], a[208:211], v[184:187], a[104:107]
    v_cvt_pk_bf16_f32 v141, v230, v231
    v_exp_f32 v232, v52
    v_mfma_f32_16x16x32_bf16 a[108:111], a[216:219], v[184:187], a[108:111]
    ds_read_b64_tr_b16 a[240:241], v241 offset:192
    ds_read_b64_tr_b16 a[242:243], v241 offset:448
    v_exp_f32 v233, v53
    v_mfma_f32_16x16x32_bf16 a[108:111], a[220:223], v[188:191], a[108:111]
    v_cvt_pk_bf16_f32 v142, v232, v233
    v_exp_f32 v234, v54
    v_mfma_f32_16x16x32_bf16 a[76:79], a[220:223], v[180:183], a[76:79]
    ds_read_b64_tr_b16 a[244:245], v241 offset:704
    ds_read_b64_tr_b16 a[246:247], v241 offset:960
    v_exp_f32 v235, v55
    v_mfma_f32_16x16x32_bf16 a[76:79], a[216:219], v[176:179], a[76:79]
    v_cvt_pk_bf16_f32 v143, v234, v235
    v_exp_f32 v228, v8
    v_exp_f32 v229, v9
    v_mfma_f32_16x16x32_bf16 a[44:47], a[216:219], v[168:171], a[44:47]
    ds_read_b64_tr_b16 a[248:249], v241 offset:224
    ds_read_b64_tr_b16 a[250:251], v241 offset:480
    v_cvt_pk_bf16_f32 v144, v228, v229
    v_exp_f32 v230, v10
    v_mfma_f32_16x16x32_bf16 a[44:47], a[220:223], v[172:175], a[44:47]
    v_exp_f32 v231, v11
    v_smfmac_f32_16x16x64_bf16 v[212:215], v[236:239], v[136:143], v245
    v_cvt_pk_bf16_f32 v145, v230, v231
    v_mfma_f32_16x16x32_bf16 a[12:15], a[220:223], v[164:167], a[12:15]
    ds_read_b64_tr_b16 a[252:253], v241 offset:736
    ds_read_b64_tr_b16 a[254:255], v241 offset:992
    v_exp_f32 v232, v24
    v_mfma_f32_16x16x32_bf16 a[12:15], a[216:219], v[160:163], a[12:15]
    v_exp_f32 v233, v25
    s_waitcnt lgkmcnt(8)
    v_mfma_f32_16x16x32_bf16 a[16:19], a[224:227], v[160:163], a[16:19]
    v_cvt_pk_bf16_f32 v146, v232, v233
    v_exp_f32 v234, v26
    v_exp_f32 v235, v27
    v_mfma_f32_16x16x32_bf16 a[16:19], a[228:231], v[164:167], a[16:19]
    v_cvt_pk_bf16_f32 v147, v234, v235
    v_exp_f32 v228, v40
    v_mfma_f32_16x16x32_bf16 a[48:51], a[228:231], v[172:175], a[48:51]
    v_exp_f32 v229, v41
    v_mfma_f32_16x16x32_bf16 a[48:51], a[224:227], v[168:171], a[48:51]
    v_cvt_pk_bf16_f32 v148, v228, v229
    v_exp_f32 v230, v42
    v_mfma_f32_16x16x32_bf16 a[80:83], a[224:227], v[176:179], a[80:83]
    v_exp_f32 v231, v43
    v_mfma_f32_16x16x32_bf16 a[80:83], a[228:231], v[180:183], a[80:83]
    v_cvt_pk_bf16_f32 v149, v230, v231
    v_exp_f32 v232, v56
    v_exp_f32 v233, v57
    v_mfma_f32_16x16x32_bf16 a[112:115], a[228:231], v[188:191], a[112:115]
    v_cvt_pk_bf16_f32 v150, v232, v233
    v_exp_f32 v234, v58
    v_mfma_f32_16x16x32_bf16 a[112:115], a[224:227], v[184:187], a[112:115]
    v_exp_f32 v235, v59
    v_mfma_f32_16x16x32_bf16 a[116:119], a[232:235], v[184:187], a[116:119]
    v_cvt_pk_bf16_f32 v151, v234, v235
    v_exp_f32 v228, v12
    v_mfma_f32_16x16x32_bf16 a[116:119], a[236:239], v[188:191], a[116:119]
    v_exp_f32 v229, v13
    v_mfma_f32_16x16x32_bf16 a[84:87], a[236:239], v[180:183], a[84:87]
    v_cvt_pk_bf16_f32 v152, v228, v229
    v_exp_f32 v230, v14
    v_smfmac_f32_16x16x64_bf16 v[216:219], v[236:239], v[144:151], v245
    v_mfma_f32_16x16x32_bf16 a[84:87], a[232:235], v[176:179], a[84:87]
    v_exp_f32 v231, v15
    v_exp_f32 v232, v28
    v_mfma_f32_16x16x32_bf16 a[52:55], a[232:235], v[168:171], a[52:55]
    v_cvt_pk_bf16_f32 v153, v230, v231
    v_exp_f32 v233, v29
    v_mfma_f32_16x16x32_bf16 a[52:55], a[236:239], v[172:175], a[52:55]
    v_cvt_pk_bf16_f32 v154, v232, v233
    v_exp_f32 v234, v30
    v_mfma_f32_16x16x32_bf16 a[20:23], a[236:239], v[164:167], a[20:23]
    v_exp_f32 v235, v31
    v_mfma_f32_16x16x32_bf16 a[20:23], a[232:235], v[160:163], a[20:23]
    v_cvt_pk_bf16_f32 v155, v234, v235
    v_exp_f32 v228, v44
    s_waitcnt lgkmcnt(0)
    v_mfma_f32_16x16x32_bf16 a[24:27], a[240:243], v[160:163], a[24:27]
    v_exp_f32 v229, v45
    v_exp_f32 v230, v46
    v_mfma_f32_16x16x32_bf16 a[24:27], a[244:247], v[164:167], a[24:27]
    v_cvt_pk_bf16_f32 v156, v228, v229
    v_exp_f32 v231, v47
    v_mfma_f32_16x16x32_bf16 a[56:59], a[244:247], v[172:175], a[56:59]
    s_waitcnt vmcnt(8) lgkmcnt(0)
    s_barrier
    v_mfma_f32_16x16x32_bf16 a[56:59], a[240:243], v[168:171], a[56:59]
    ds_read_b128 a[192:195], v240 offset:0
    ds_read_b128 a[196:199], v240 offset:16
    s_mov_b32 s54, 49152
    s_add_u32 m0, s25, 0
    v_cvt_pk_bf16_f32 v157, v230, v231
    v_exp_f32 v232, v60
    v_exp_f32 v233, v61
    v_mfma_f32_16x16x32_bf16 a[88:91], a[240:243], v[176:179], a[88:91]
    ds_read_b128 a[200:203], v240 offset:32
    ds_read_b128 a[204:207], v240 offset:48
    buffer_load_dwordx4 v244, s[16:19], s54 offen nt lds
    s_add_u32 m0, s25, 16
    v_cvt_pk_bf16_f32 v158, v232, v233
    v_exp_f32 v234, v62
    v_mfma_f32_16x16x32_bf16 a[88:91], a[244:247], v[180:183], a[88:91]
    v_exp_f32 v235, v63
    v_mfma_f32_16x16x32_bf16 a[120:123], a[244:247], v[188:191], a[120:123]
    v_cvt_pk_bf16_f32 v159, v234, v235
    v_mfma_f32_16x16x32_bf16 a[120:123], a[240:243], v[184:187], a[120:123]
    v_mfma_f32_16x16x32_bf16 a[124:127], a[248:251], v[184:187], a[124:127]
    ds_read_b128 a[208:211], v240 offset:256
    buffer_load_dwordx4 v244, s[16:19], s54 offen offset:1024 nt lds
    s_add_u32 m0, s25, 32
    v_smfmac_f32_16x16x64_bf16 v[220:223], v[236:239], v[152:159], v245
    v_add_f32 v224, v208, v209
    v_add_f32 v225, v212, v213
    v_mfma_f32_16x16x32_bf16 a[124:127], a[252:255], v[188:191], a[124:127]
    v_add_f32 v226, v216, v217
    v_max3_f32 v246, v224, v225, v226
    v_mfma_f32_16x16x32_bf16 a[92:95], a[252:255], v[180:183], a[92:95]
    ds_read_b128 a[212:215], v240 offset:272
    v_mfma_f32_16x16x32_bf16 a[92:95], a[248:251], v[176:179], a[92:95]
    v_mfma_f32_16x16x32_bf16 a[60:63], a[248:251], v[168:171], a[60:63]
    ds_read_b128 a[216:219], v240 offset:288
    buffer_load_dwordx4 v244, s[16:19], s54 offen offset:2048 nt lds
    s_add_u32 m0, s25, 48
    v_mfma_f32_16x16x32_bf16 a[60:63], a[252:255], v[172:175], a[60:63]
    v_add_f32 v227, v220, v221
    v_max_f32 v246, v246, v227
    v_mfma_f32_16x16x32_bf16 a[28:31], a[252:255], v[164:167], a[28:31]
    ds_read_b128 a[220:223], v240 offset:304
    v_cmp_nge_f32 vcc, s28, v246
    v_mfma_f32_16x16x32_bf16 a[28:31], a[248:251], v[160:163], a[28:31]
    s_waitcnt lgkmcnt(4)
    v_mfma_f32_16x16x32_bf16 v[64:67], a[192:195], a[128:131], v[192:195]
    buffer_load_dwordx4 v244, s[16:19], s54 offen offset:3072 nt lds
    v_mfma_f32_16x16x32_bf16 v[64:67], a[196:199], a[132:135], v[64:67]
    v_mfma_f32_16x16x32_bf16 v[64:67], a[200:203], a[136:139], v[64:67]
    v_add_u32 v241, 66560, v243
    v_mfma_f32_16x16x32_bf16 v[64:67], a[204:207], a[140:143], v[64:67]
    v_mfma_f32_16x16x32_bf16 v[68:71], a[204:207], a[156:159], v[196:199]
    v_mfma_f32_16x16x32_bf16 v[68:71], a[200:203], a[152:155], v[68:71]
    v_mfma_f32_16x16x32_bf16 v[68:71], a[196:199], a[148:151], v[68:71]
    v_mfma_f32_16x16x32_bf16 v[68:71], a[192:195], a[144:147], v[68:71]
    v_mfma_f32_16x16x32_bf16 v[72:75], a[192:195], a[160:163], v[200:203]
    ds_read_b128 a[224:227], v240 offset:512
    v_mfma_f32_16x16x32_bf16 v[72:75], a[196:199], a[164:167], v[72:75]
    v_mfma_f32_16x16x32_bf16 v[72:75], a[200:203], a[168:171], v[72:75]
    ds_read_b128 a[228:231], v240 offset:528
    v_mfma_f32_16x16x32_bf16 v[72:75], a[204:207], a[172:175], v[72:75]
    v_mfma_f32_16x16x32_bf16 v[76:79], a[204:207], a[188:191], v[204:207]
    ds_read_b128 a[232:235], v240 offset:544
    v_mfma_f32_16x16x32_bf16 v[76:79], a[200:203], a[184:187], v[76:79]
    v_mfma_f32_16x16x32_bf16 v[76:79], a[196:199], a[180:183], v[76:79]
    ds_read_b128 a[236:239], v240 offset:560
    v_mfma_f32_16x16x32_bf16 v[76:79], a[192:195], a[176:179], v[76:79]
    s_waitcnt lgkmcnt(4)
    v_mfma_f32_16x16x32_bf16 v[92:95], a[208:211], a[176:179], v[204:207]
    v_mfma_f32_16x16x32_bf16 v[92:95], a[212:215], a[180:183], v[92:95]
    v_mfma_f32_16x16x32_bf16 v[92:95], a[216:219], a[184:187], v[92:95]
    v_mfma_f32_16x16x32_bf16 v[92:95], a[220:223], a[188:191], v[92:95]
    v_mfma_f32_16x16x32_bf16 v[88:91], a[220:223], a[172:175], v[200:203]
    v_mfma_f32_16x16x32_bf16 v[88:91], a[216:219], a[168:171], v[88:91]
    v_mfma_f32_16x16x32_bf16 v[88:91], a[212:215], a[164:167], v[88:91]
    v_mfma_f32_16x16x32_bf16 v[88:91], a[208:211], a[160:163], v[88:91]
    v_mfma_f32_16x16x32_bf16 v[84:87], a[208:211], a[144:147], v[196:199]
    ds_read_b128 a[240:243], v240 offset:768
    v_mfma_f32_16x16x32_bf16 v[84:87], a[212:215], a[148:151], v[84:87]
    v_mfma_f32_16x16x32_bf16 v[84:87], a[216:219], a[152:155], v[84:87]
    ds_read_b128 a[244:247], v240 offset:784
    v_mfma_f32_16x16x32_bf16 v[84:87], a[220:223], a[156:159], v[84:87]
    v_mfma_f32_16x16x32_bf16 v[80:83], a[220:223], a[140:143], v[192:195]
    ds_read_b128 a[248:251], v240 offset:800
    v_mfma_f32_16x16x32_bf16 v[80:83], a[216:219], a[136:139], v[80:83]
    v_mfma_f32_16x16x32_bf16 v[80:83], a[212:215], a[132:135], v[80:83]
    ds_read_b128 a[252:255], v240 offset:816
    v_mfma_f32_16x16x32_bf16 v[80:83], a[208:211], a[128:131], v[80:83]
    s_waitcnt lgkmcnt(4)
    v_mfma_f32_16x16x32_bf16 v[96:99], a[224:227], a[128:131], v[192:195]
    v_mfma_f32_16x16x32_bf16 v[96:99], a[228:231], a[132:135], v[96:99]
    v_mfma_f32_16x16x32_bf16 v[96:99], a[232:235], a[136:139], v[96:99]
    v_mfma_f32_16x16x32_bf16 v[96:99], a[236:239], a[140:143], v[96:99]
    v_mfma_f32_16x16x32_bf16 v[100:103], a[236:239], a[156:159], v[196:199]
    v_mfma_f32_16x16x32_bf16 v[100:103], a[232:235], a[152:155], v[100:103]
    v_mfma_f32_16x16x32_bf16 v[100:103], a[228:231], a[148:151], v[100:103]
    v_mfma_f32_16x16x32_bf16 v[100:103], a[224:227], a[144:147], v[100:103]
    v_mfma_f32_16x16x32_bf16 v[104:107], a[224:227], a[160:163], v[200:203]
    v_mfma_f32_16x16x32_bf16 v[104:107], a[228:231], a[164:167], v[104:107]
    v_mfma_f32_16x16x32_bf16 v[104:107], a[232:235], a[168:171], v[104:107]
    v_mfma_f32_16x16x32_bf16 v[104:107], a[236:239], a[172:175], v[104:107]
    v_mfma_f32_16x16x32_bf16 v[108:111], a[236:239], a[188:191], v[204:207]
    v_mfma_f32_16x16x32_bf16 v[108:111], a[232:235], a[184:187], v[108:111]
    v_mfma_f32_16x16x32_bf16 v[108:111], a[228:231], a[180:183], v[108:111]
    v_mfma_f32_16x16x32_bf16 v[108:111], a[224:227], a[176:179], v[108:111]
    s_waitcnt lgkmcnt(0)
    v_mfma_f32_16x16x32_bf16 v[124:127], a[240:243], a[176:179], v[204:207]
    v_mfma_f32_16x16x32_bf16 v[124:127], a[244:247], a[180:183], v[124:127]
    v_mfma_f32_16x16x32_bf16 v[124:127], a[248:251], a[184:187], v[124:127]
    s_waitcnt vmcnt(8) lgkmcnt(0)
    s_barrier
    v_mfma_f32_16x16x32_bf16 v[124:127], a[252:255], a[188:191], v[124:127]
    ds_read_b64_tr_b16 a[192:193], v241 offset:0
    ds_read_b64_tr_b16 a[194:195], v241 offset:256
    s_mov_b32 s54, 81920
    s_add_u32 m0, s25, 16640
    v_mfma_f32_16x16x32_bf16 v[120:123], a[252:255], a[172:175], v[200:203]
    ds_read_b64_tr_b16 a[196:197], v241 offset:512
    ds_read_b64_tr_b16 a[198:199], v241 offset:768
    buffer_load_dwordx4 v244, s[12:15], s54 offen nt lds
    s_add_u32 m0, s25, 16656
    v_mfma_f32_16x16x32_bf16 v[120:123], a[248:251], a[168:171], v[120:123]
    ds_read_b64_tr_b16 a[200:201], v241 offset:32
    ds_read_b64_tr_b16 a[202:203], v241 offset:288
    v_mfma_f32_16x16x32_bf16 v[120:123], a[244:247], a[164:167], v[120:123]
    ds_read_b64_tr_b16 a[204:205], v241 offset:544
    ds_read_b64_tr_b16 a[206:207], v241 offset:800
    v_mfma_f32_16x16x32_bf16 v[120:123], a[240:243], a[160:163], v[120:123]
    v_mfma_f32_16x16x32_bf16 v[116:119], a[240:243], a[144:147], v[196:199]
    ds_read_b64_tr_b16 a[208:209], v241 offset:64
    ds_read_b64_tr_b16 a[210:211], v241 offset:320
    buffer_load_dwordx4 v244, s[12:15], s54 offen offset:1024 nt lds
    s_add_u32 m0, s25, 16672
    v_mfma_f32_16x16x32_bf16 v[116:119], a[244:247], a[148:151], v[116:119]
    v_mfma_f32_16x16x32_bf16 v[116:119], a[248:251], a[152:155], v[116:119]
    ds_read_b64_tr_b16 a[212:213], v241 offset:576
    ds_read_b64_tr_b16 a[214:215], v241 offset:832
    v_mfma_f32_16x16x32_bf16 v[116:119], a[252:255], a[156:159], v[116:119]
    v_mfma_f32_16x16x32_bf16 v[112:115], a[252:255], a[140:143], v[192:195]
    ds_read_b64_tr_b16 a[216:217], v241 offset:96
    ds_read_b64_tr_b16 a[218:219], v241 offset:352
    buffer_load_dwordx4 v244, s[12:15], s54 offen offset:2048 nt lds
    s_add_u32 m0, s25, 16688
    v_mfma_f32_16x16x32_bf16 v[112:115], a[248:251], a[136:139], v[112:115]
    v_mfma_f32_16x16x32_bf16 v[112:115], a[244:247], a[132:135], v[112:115]
    ds_read_b64_tr_b16 a[220:221], v241 offset:608
    ds_read_b64_tr_b16 a[222:223], v241 offset:864
    v_mfma_f32_16x16x32_bf16 v[112:115], a[240:243], a[128:131], v[112:115]
    s_cbranch_vccnz L_fb_r2
L_r2:
    s_waitcnt lgkmcnt(8)
    v_mfma_f32_16x16x32_bf16 a[0:3], a[192:195], v[128:131], a[0:3]
    buffer_load_dwordx4 v244, s[12:15], s54 offen offset:3072 nt lds
    v_exp_f32 v228, v64
    v_exp_f32 v229, v65
    v_mfma_f32_16x16x32_bf16 a[0:3], a[196:199], v[132:135], a[0:3]
    v_cvt_pk_bf16_f32 v160, v228, v229
    v_exp_f32 v230, v66
    v_mfma_f32_16x16x32_bf16 a[32:35], a[196:199], v[140:143], a[32:35]
    v_add_u32 v240, 83200, v242
    v_exp_f32 v231, v67
    v_mfma_f32_16x16x32_bf16 a[32:35], a[192:195], v[136:139], a[32:35]
    v_cvt_pk_bf16_f32 v161, v230, v231
    v_exp_f32 v232, v80
    v_mfma_f32_16x16x32_bf16 a[64:67], a[192:195], v[144:147], a[64:67]
    v_exp_f32 v233, v81
    v_mfma_f32_16x16x32_bf16 a[64:67], a[196:199], v[148:151], a[64:67]
    v_cvt_pk_bf16_f32 v162, v232, v233
    v_exp_f32 v234, v82
    v_exp_f32 v235, v83
    v_mfma_f32_16x16x32_bf16 a[96:99], a[196:199], v[156:159], a[96:99]
    v_cvt_pk_bf16_f32 v163, v234, v235
    v_exp_f32 v228, v96
    v_mfma_f32_16x16x32_bf16 a[96:99], a[192:195], v[152:155], a[96:99]
    v_exp_f32 v229, v97
    v_mfma_f32_16x16x32_bf16 a[100:103], a[200:203], v[152:155], a[100:103]
    ds_read_b64_tr_b16 a[224:225], v241 offset:128
    ds_read_b64_tr_b16 a[226:227], v241 offset:384
    v_cvt_pk_bf16_f32 v164, v228, v229
    v_exp_f32 v230, v98
    v_mfma_f32_16x16x32_bf16 a[100:103], a[204:207], v[156:159], a[100:103]
    v_exp_f32 v231, v99
    v_mfma_f32_16x16x32_bf16 a[68:71], a[204:207], v[148:151], a[68:71]
    ds_read_b64_tr_b16 a[228:229], v241 offset:640
    ds_read_b64_tr_b16 a[230:231], v241 offset:896
    v_cvt_pk_bf16_f32 v165, v230, v231
    v_exp_f32 v232, v112
    v_exp_f32 v233, v113
    v_mfma_f32_16x16x32_bf16 a[68:71], a[200:203], v[144:147], a[68:71]
    v_cvt_pk_bf16_f32 v166, v232, v233
    v_exp_f32 v234, v114
    v_mfma_f32_16x16x32_bf16 a[36:39], a[200:203], v[136:139], a[36:39]
    ds_read_b64_tr_b16 a[232:233], v241 offset:160
    ds_read_b64_tr_b16 a[234:235], v241 offset:416
    v_exp_f32 v235, v115
    v_mfma_f32_16x16x32_bf16 a[36:39], a[204:207], v[140:143], a[36:39]
    v_cvt_pk_bf16_f32 v167, v234, v235
    v_exp_f32 v228, v68
    v_mfma_f32_16x16x32_bf16 a[4:7], a[204:207], v[132:135], a[4:7]
    ds_read_b64_tr_b16 a[236:237], v241 offset:672
    ds_read_b64_tr_b16 a[238:239], v241 offset:928
    v_exp_f32 v229, v69
    v_mfma_f32_16x16x32_bf16 a[4:7], a[200:203], v[128:131], a[4:7]
    v_cvt_pk_bf16_f32 v168, v228, v229
    v_exp_f32 v230, v70
    v_smfmac_f32_16x16x64_bf16 v[208:211], v[236:239], v[160:167], v245
    s_waitcnt lgkmcnt(8)
    v_mfma_f32_16x16x32_bf16 a[8:11], a[208:211], v[128:131], a[8:11]
    v_exp_f32 v231, v71
    v_exp_f32 v232, v84
    v_mfma_f32_16x16x32_bf16 a[8:11], a[212:215], v[132:135], a[8:11]
    v_cvt_pk_bf16_f32 v169, v230, v231
    v_exp_f32 v233, v85
    v_mfma_f32_16x16x32_bf16 a[40:43], a[212:215], v[140:143], a[40:43]
    v_cvt_pk_bf16_f32 v170, v232, v233
    v_exp_f32 v234, v86
    v_mfma_f32_16x16x32_bf16 a[40:43], a[208:211], v[136:139], a[40:43]
    v_exp_f32 v235, v87
    v_mfma_f32_16x16x32_bf16 a[72:75], a[208:211], v[144:147], a[72:75]
    v_cvt_pk_bf16_f32 v171, v234, v235
    v_exp_f32 v228, v100
    v_mfma_f32_16x16x32_bf16 a[72:75], a[212:215], v[148:151], a[72:75]
    v_exp_f32 v229, v101
    v_exp_f32 v230, v102
    v_mfma_f32_16x16x32_bf16 a[104:107], a[212:215], v[156:159], a[104:107]
    v_cvt_pk_bf16_f32 v172, v228, v229
    v_exp_f32 v231, v103
    v_mfma_f32_16x16x32_bf16 a[104:107], a[208:211], v[152:155], a[104:107]
    v_cvt_pk_bf16_f32 v173, v230, v231
    v_exp_f32 v232, v116
    v_mfma_f32_16x16x32_bf16 a[108:111], a[216:219], v[152:155], a[108:111]
    ds_read_b64_tr_b16 a[240:241], v241 offset:192
    ds_read_b64_tr_b16 a[242:243], v241 offset:448
    v_exp_f32 v233, v117
    v_mfma_f32_16x16x32_bf16 a[108:111], a[220:223], v[156:159], a[108:111]
    v_cvt_pk_bf16_f32 v174, v232, v233
    v_exp_f32 v234, v118
    v_mfma_f32_16x16x32_bf16 a[76:79], a[220:223], v[148:151], a[76:79]
    ds_read_b64_tr_b16 a[244:245], v241 offset:704
    ds_read_b64_tr_b16 a[246:247], v241 offset:960
    v_exp_f32 v235, v119
    v_mfma_f32_16x16x32_bf16 a[76:79], a[216:219], v[144:147], a[76:79]
    v_cvt_pk_bf16_f32 v175, v234, v235
    v_exp_f32 v228, v72
    v_exp_f32 v229, v73
    v_mfma_f32_16x16x32_bf16 a[44:47], a[216:219], v[136:139], a[44:47]
    ds_read_b64_tr_b16 a[248:249], v241 offset:224
    ds_read_b64_tr_b16 a[250:251], v241 offset:480
    v_cvt_pk_bf16_f32 v176, v228, v229
    v_exp_f32 v230, v74
    v_mfma_f32_16x16x32_bf16 a[44:47], a[220:223], v[140:143], a[44:47]
    v_exp_f32 v231, v75
    v_smfmac_f32_16x16x64_bf16 v[212:215], v[236:239], v[168:175], v245
    v_cvt_pk_bf16_f32 v177, v230, v231
    v_mfma_f32_16x16x32_bf16 a[12:15], a[220:223], v[132:135], a[12:15]
    ds_read_b64_tr_b16 a[252:253], v241 offset:736
    ds_read_b64_tr_b16 a[254:255], v241 offset:992
    v_exp_f32 v232, v88
    v_mfma_f32_16x16x32_bf16 a[12:15], a[216:219], v[128:131], a[12:15]
    v_exp_f32 v233, v89
    s_waitcnt lgkmcnt(8)
    v_mfma_f32_16x16x32_bf16 a[16:19], a[224:227], v[128:131], a[16:19]
    v_cvt_pk_bf16_f32 v178, v232, v233
    v_exp_f32 v234, v90
    v_exp_f32 v235, v91
    v_mfma_f32_16x16x32_bf16 a[16:19], a[228:231], v[132:135], a[16:19]
    v_cvt_pk_bf16_f32 v179, v234, v235
    v_exp_f32 v228, v104
    v_mfma_f32_16x16x32_bf16 a[48:51], a[228:231], v[140:143], a[48:51]
    v_exp_f32 v229, v105
    v_mfma_f32_16x16x32_bf16 a[48:51], a[224:227], v[136:139], a[48:51]
    v_cvt_pk_bf16_f32 v180, v228, v229
    v_exp_f32 v230, v106
    v_mfma_f32_16x16x32_bf16 a[80:83], a[224:227], v[144:147], a[80:83]
    v_exp_f32 v231, v107
    v_mfma_f32_16x16x32_bf16 a[80:83], a[228:231], v[148:151], a[80:83]
    v_cvt_pk_bf16_f32 v181, v230, v231
    v_exp_f32 v232, v120
    v_exp_f32 v233, v121
    v_mfma_f32_16x16x32_bf16 a[112:115], a[228:231], v[156:159], a[112:115]
    v_cvt_pk_bf16_f32 v182, v232, v233
    v_exp_f32 v234, v122
    v_mfma_f32_16x16x32_bf16 a[112:115], a[224:227], v[152:155], a[112:115]
    v_exp_f32 v235, v123
    v_mfma_f32_16x16x32_bf16 a[116:119], a[232:235], v[152:155], a[116:119]
    v_cvt_pk_bf16_f32 v183, v234, v235
    v_exp_f32 v228, v76
    v_mfma_f32_16x16x32_bf16 a[116:119], a[236:239], v[156:159], a[116:119]
    v_exp_f32 v229, v77
    v_mfma_f32_16x16x32_bf16 a[84:87], a[236:239], v[148:151], a[84:87]
    v_cvt_pk_bf16_f32 v184, v228, v229
    v_exp_f32 v230, v78
    v_smfmac_f32_16x16x64_bf16 v[216:219], v[236:239], v[176:183], v245
    v_mfma_f32_16x16x32_bf16 a[84:87], a[232:235], v[144:147], a[84:87]
    v_exp_f32 v231, v79
    v_exp_f32 v232, v92
    v_mfma_f32_16x16x32_bf16 a[52:55], a[232:235], v[136:139], a[52:55]
    v_cvt_pk_bf16_f32 v185, v230, v231
    v_exp_f32 v233, v93
    v_mfma_f32_16x16x32_bf16 a[52:55], a[236:239], v[140:143], a[52:55]
    v_cvt_pk_bf16_f32 v186, v232, v233
    v_exp_f32 v234, v94
    v_mfma_f32_16x16x32_bf16 a[20:23], a[236:239], v[132:135], a[20:23]
    v_exp_f32 v235, v95
    v_mfma_f32_16x16x32_bf16 a[20:23], a[232:235], v[128:131], a[20:23]
    v_cvt_pk_bf16_f32 v187, v234, v235
    v_exp_f32 v228, v108
    s_waitcnt lgkmcnt(0)
    v_mfma_f32_16x16x32_bf16 a[24:27], a[240:243], v[128:131], a[24:27]
    v_exp_f32 v229, v109
    v_exp_f32 v230, v110
    v_mfma_f32_16x16x32_bf16 a[24:27], a[244:247], v[132:135], a[24:27]
    v_cvt_pk_bf16_f32 v188, v228, v229
    v_exp_f32 v231, v111
    v_mfma_f32_16x16x32_bf16 a[56:59], a[244:247], v[140:143], a[56:59]
    s_waitcnt vmcnt(8) lgkmcnt(0)
    s_barrier
    v_mfma_f32_16x16x32_bf16 a[56:59], a[240:243], v[136:139], a[56:59]
    ds_read_b128 a[192:195], v240 offset:0
    ds_read_b128 a[196:199], v240 offset:16
    s_mov_b32 s54, 65536
    s_add_u32 m0, s25, 33280
    v_cvt_pk_bf16_f32 v189, v230, v231
    v_exp_f32 v232, v124
    v_exp_f32 v233, v125
    v_mfma_f32_16x16x32_bf16 a[88:91], a[240:243], v[144:147], a[88:91]
    ds_read_b128 a[200:203], v240 offset:32
    ds_read_b128 a[204:207], v240 offset:48
    buffer_load_dwordx4 v244, s[16:19], s54 offen nt lds
    s_add_u32 m0, s25, 33296
    v_cvt_pk_bf16_f32 v190, v232, v233
    v_exp_f32 v234, v126
    v_mfma_f32_16x16x32_bf16 a[88:91], a[244:247], v[148:151], a[88:91]
    v_exp_f32 v235, v127
    v_mfma_f32_16x16x32_bf16 a[120:123], a[244:247], v[156:159], a[120:123]
    v_cvt_pk_bf16_f32 v191, v234, v235
    v_mfma_f32_16x16x32_bf16 a[120:123], a[240:243], v[152:155], a[120:123]
    v_mfma_f32_16x16x32_bf16 a[124:127], a[248:251], v[152:155], a[124:127]
    ds_read_b128 a[208:211], v240 offset:256
    buffer_load_dwordx4 v244, s[16:19], s54 offen offset:1024 nt lds
    s_add_u32 m0, s25, 33312
    v_smfmac_f32_16x16x64_bf16 v[220:223], v[236:239], v[184:191], v245
    v_add_f32 v248, v208, v209
    v_add_f32 v249, v212, v213
    v_mfma_f32_16x16x32_bf16 a[124:127], a[252:255], v[156:159], a[124:127]
    v_add_f32 v250, v216, v217
    v_max3_f32 v246, v248, v249, v250
    v_mfma_f32_16x16x32_bf16 a[92:95], a[252:255], v[148:151], a[92:95]
    ds_read_b128 a[212:215], v240 offset:272
    v_mfma_f32_16x16x32_bf16 a[92:95], a[248:251], v[144:147], a[92:95]
    v_mfma_f32_16x16x32_bf16 a[60:63], a[248:251], v[136:139], a[60:63]
    ds_read_b128 a[216:219], v240 offset:288
    buffer_load_dwordx4 v244, s[16:19], s54 offen offset:2048 nt lds
    s_add_u32 m0, s25, 33328
    v_mfma_f32_16x16x32_bf16 a[60:63], a[252:255], v[140:143], a[60:63]
    v_add_f32 v251, v220, v221
    v_max_f32 v246, v246, v251
    v_mfma_f32_16x16x32_bf16 a[28:31], a[252:255], v[132:135], a[28:31]
    ds_read_b128 a[220:223], v240 offset:304
    v_cmp_nge_f32 vcc, s28, v246
    v_mfma_f32_16x16x32_bf16 a[28:31], a[248:251], v[128:131], a[28:31]
    s_waitcnt lgkmcnt(4)
    v_mfma_f32_16x16x32_bf16 v[0:3], a[192:195], a[128:131], v[192:195]
    buffer_load_dwordx4 v244, s[16:19], s54 offen offset:3072 nt lds
    v_mfma_f32_16x16x32_bf16 v[0:3], a[196:199], a[132:135], v[0:3]
    v_mfma_f32_16x16x32_bf16 v[0:3], a[200:203], a[136:139], v[0:3]
    v_add_u32 v241, 0, v243
    v_mfma_f32_16x16x32_bf16 v[0:3], a[204:207], a[140:143], v[0:3]
    v_mfma_f32_16x16x32_bf16 v[4:7], a[204:207], a[156:159], v[196:199]
    v_mfma_f32_16x16x32_bf16 v[4:7], a[200:203], a[152:155], v[4:7]
    v_mfma_f32_16x16x32_bf16 v[4:7], a[196:199], a[148:151], v[4:7]
    v_mfma_f32_16x16x32_bf16 v[4:7], a[192:195], a[144:147], v[4:7]
    v_mfma_f32_16x16x32_bf16 v[8:11], a[192:195], a[160:163], v[200:203]
    ds_read_b128 a[224:227], v240 offset:512
    v_mfma_f32_16x16x32_bf16 v[8:11], a[196:199], a[164:167], v[8:11]
    v_mfma_f32_16x16x32_bf16 v[8:11], a[200:203], a[168:171], v[8:11]
    ds_read_b128 a[228:231], v240 offset:528
    v_mfma_f32_16x16x32_bf16 v[8:11], a[204:207], a[172:175], v[8:11]
    v_mfma_f32_16x16x32_bf16 v[12:15], a[204:207], a[188:191], v[204:207]
    ds_read_b128 a[232:235], v240 offset:544
    v_mfma_f32_16x16x32_bf16 v[12:15], a[200:203], a[184:187], v[12:15]
    v_mfma_f32_16x16x32_bf16 v[12:15], a[196:199], a[180:183], v[12:15]
    ds_read_b128 a[236:239], v240 offset:560
    v_mfma_f32_16x16x32_bf16 v[12:15], a[192:195], a[176:179], v[12:15]
    s_waitcnt lgkmcnt(4)
    v_mfma_f32_16x16x32_bf16 v[28:31], a[208:211], a[176:179], v[204:207]
    v_mfma_f32_16x16x32_bf16 v[28:31], a[212:215], a[180:183], v[28:31]
    v_mfma_f32_16x16x32_bf16 v[28:31], a[216:219], a[184:187], v[28:31]
    v_mfma_f32_16x16x32_bf16 v[28:31], a[220:223], a[188:191], v[28:31]
    v_mfma_f32_16x16x32_bf16 v[24:27], a[220:223], a[172:175], v[200:203]
    v_mfma_f32_16x16x32_bf16 v[24:27], a[216:219], a[168:171], v[24:27]
    v_mfma_f32_16x16x32_bf16 v[24:27], a[212:215], a[164:167], v[24:27]
    v_mfma_f32_16x16x32_bf16 v[24:27], a[208:211], a[160:163], v[24:27]
    v_mfma_f32_16x16x32_bf16 v[20:23], a[208:211], a[144:147], v[196:199]
    ds_read_b128 a[240:243], v240 offset:768
    v_mfma_f32_16x16x32_bf16 v[20:23], a[212:215], a[148:151], v[20:23]
    v_mfma_f32_16x16x32_bf16 v[20:23], a[216:219], a[152:155], v[20:23]
    ds_read_b128 a[244:247], v240 offset:784
    v_mfma_f32_16x16x32_bf16 v[20:23], a[220:223], a[156:159], v[20:23]
    v_mfma_f32_16x16x32_bf16 v[16:19], a[220:223], a[140:143], v[192:195]
    ds_read_b128 a[248:251], v240 offset:800
    v_mfma_f32_16x16x32_bf16 v[16:19], a[216:219], a[136:139], v[16:19]
    v_mfma_f32_16x16x32_bf16 v[16:19], a[212:215], a[132:135], v[16:19]
    ds_read_b128 a[252:255], v240 offset:816
    v_mfma_f32_16x16x32_bf16 v[16:19], a[208:211], a[128:131], v[16:19]
    s_waitcnt lgkmcnt(4)
    v_mfma_f32_16x16x32_bf16 v[32:35], a[224:227], a[128:131], v[192:195]
    v_mfma_f32_16x16x32_bf16 v[32:35], a[228:231], a[132:135], v[32:35]
    v_mfma_f32_16x16x32_bf16 v[32:35], a[232:235], a[136:139], v[32:35]
    v_mfma_f32_16x16x32_bf16 v[32:35], a[236:239], a[140:143], v[32:35]
    v_mfma_f32_16x16x32_bf16 v[36:39], a[236:239], a[156:159], v[196:199]
    v_mfma_f32_16x16x32_bf16 v[36:39], a[232:235], a[152:155], v[36:39]
    v_mfma_f32_16x16x32_bf16 v[36:39], a[228:231], a[148:151], v[36:39]
    v_mfma_f32_16x16x32_bf16 v[36:39], a[224:227], a[144:147], v[36:39]
    v_mfma_f32_16x16x32_bf16 v[40:43], a[224:227], a[160:163], v[200:203]
    v_mfma_f32_16x16x32_bf16 v[40:43], a[228:231], a[164:167], v[40:43]
    v_mfma_f32_16x16x32_bf16 v[40:43], a[232:235], a[168:171], v[40:43]
    v_mfma_f32_16x16x32_bf16 v[40:43], a[236:239], a[172:175], v[40:43]
    v_mfma_f32_16x16x32_bf16 v[44:47], a[236:239], a[188:191], v[204:207]
    v_mfma_f32_16x16x32_bf16 v[44:47], a[232:235], a[184:187], v[44:47]
    v_mfma_f32_16x16x32_bf16 v[44:47], a[228:231], a[180:183], v[44:47]
    v_mfma_f32_16x16x32_bf16 v[44:47], a[224:227], a[176:179], v[44:47]
    s_waitcnt lgkmcnt(0)
    v_mfma_f32_16x16x32_bf16 v[60:63], a[240:243], a[176:179], v[204:207]
    v_mfma_f32_16x16x32_bf16 v[60:63], a[244:247], a[180:183], v[60:63]
    v_mfma_f32_16x16x32_bf16 v[60:63], a[248:251], a[184:187], v[60:63]
    s_waitcnt vmcnt(8) lgkmcnt(0)
    s_barrier
    v_mfma_f32_16x16x32_bf16 v[60:63], a[252:255], a[188:191], v[60:63]
    ds_read_b64_tr_b16 a[192:193], v241 offset:0
    ds_read_b64_tr_b16 a[194:195], v241 offset:256
    s_mov_b32 s54, 98304
    s_add_u32 m0, s25, 49920
    v_mfma_f32_16x16x32_bf16 v[56:59], a[252:255], a[172:175], v[200:203]
    ds_read_b64_tr_b16 a[196:197], v241 offset:512
    ds_read_b64_tr_b16 a[198:199], v241 offset:768
    buffer_load_dwordx4 v244, s[12:15], s54 offen nt lds
    s_add_u32 m0, s25, 49936
    v_mfma_f32_16x16x32_bf16 v[56:59], a[248:251], a[168:171], v[56:59]
    ds_read_b64_tr_b16 a[200:201], v241 offset:32
    ds_read_b64_tr_b16 a[202:203], v241 offset:288
    v_mfma_f32_16x16x32_bf16 v[56:59], a[244:247], a[164:167], v[56:59]
    ds_read_b64_tr_b16 a[204:205], v241 offset:544
    ds_read_b64_tr_b16 a[206:207], v241 offset:800
    v_mfma_f32_16x16x32_bf16 v[56:59], a[240:243], a[160:163], v[56:59]
    v_mfma_f32_16x16x32_bf16 v[52:55], a[240:243], a[144:147], v[196:199]
    ds_read_b64_tr_b16 a[208:209], v241 offset:64
    ds_read_b64_tr_b16 a[210:211], v241 offset:320
    buffer_load_dwordx4 v244, s[12:15], s54 offen offset:1024 nt lds
    s_add_u32 m0, s25, 49952
    v_mfma_f32_16x16x32_bf16 v[52:55], a[244:247], a[148:151], v[52:55]
    v_mfma_f32_16x16x32_bf16 v[52:55], a[248:251], a[152:155], v[52:55]
    ds_read_b64_tr_b16 a[212:213], v241 offset:576
    ds_read_b64_tr_b16 a[214:215], v241 offset:832
    v_mfma_f32_16x16x32_bf16 v[52:55], a[252:255], a[156:159], v[52:55]
    v_mfma_f32_16x16x32_bf16 v[48:51], a[252:255], a[140:143], v[192:195]
    ds_read_b64_tr_b16 a[216:217], v241 offset:96
    ds_read_b64_tr_b16 a[218:219], v241 offset:352
    buffer_load_dwordx4 v244, s[12:15], s54 offen offset:2048 nt lds
    s_add_u32 m0, s25, 49968
    v_mfma_f32_16x16x32_bf16 v[48:51], a[248:251], a[136:139], v[48:51]
    v_mfma_f32_16x16x32_bf16 v[48:51], a[244:247], a[132:135], v[48:51]
    ds_read_b64_tr_b16 a[220:221], v241 offset:608
    ds_read_b64_tr_b16 a[222:223], v241 offset:864
    v_mfma_f32_16x16x32_bf16 v[48:51], a[240:243], a[128:131], v[48:51]
    s_cbranch_vccnz L_fb_r3
L_r3:
    s_waitcnt lgkmcnt(8)
    v_mfma_f32_16x16x32_bf16 a[0:3], a[192:195], v[160:163], a[0:3]
    buffer_load_dwordx4 v244, s[12:15], s54 offen offset:3072 nt lds
    v_exp_f32 v228, v0
    v_mfma_f32_16x16x32_bf16 a[0:3], a[196:199], v[164:167], a[0:3]
    v_exp_f32 v229, v1
    v_mfma_f32_16x16x32_bf16 a[32:35], a[196:199], v[172:175], a[32:35]
    v_add_u32 v240, 16640, v242
    v_cvt_pk_bf16_f32 v128, v228, v229
    v_mfma_f32_16x16x32_bf16 a[32:35], a[192:195], v[168:171], a[32:35]
    v_exp_f32 v230, v2
    v_mfma_f32_16x16x32_bf16 a[64:67], a[192:195], v[176:179], a[64:67]
    v_mfma_f32_16x16x32_bf16 a[64:67], a[196:199], v[180:183], a[64:67]
    v_exp_f32 v231, v3
    v_mfma_f32_16x16x32_bf16 a[96:99], a[196:199], v[188:191], a[96:99]
    v_cvt_pk_bf16_f32 v129, v230, v231
    v_mfma_f32_16x16x32_bf16 a[96:99], a[192:195], v[184:187], a[96:99]
    v_exp_f32 v232, v16
    v_mfma_f32_16x16x32_bf16 a[100:103], a[200:203], v[184:187], a[100:103]
    ds_read_b64_tr_b16 a[224:225], v241 offset:128
    ds_read_b64_tr_b16 a[226:227], v241 offset:384
    v_exp_f32 v233, v17
    v_mfma_f32_16x16x32_bf16 a[100:103], a[204:207], v[188:191], a[100:103]
    v_cvt_pk_bf16_f32 v130, v232, v233
    v_mfma_f32_16x16x32_bf16 a[68:71], a[204:207], v[180:183], a[68:71]
    ds_read_b64_tr_b16 a[228:229], v241 offset:640
    ds_read_b64_tr_b16 a[230:231], v241 offset:896
    v_exp_f32 v234, v18
    v_mfma_f32_16x16x32_bf16 a[68:71], a[200:203], v[176:179], a[68:71]
    v_mfma_f32_16x16x32_bf16 a[36:39], a[200:203], v[168:171], a[36:39]
    ds_read_b64_tr_b16 a[232:233], v241 offset:160
    ds_read_b64_tr_b16 a[234:235], v241 offset:416
    v_exp_f32 v235, v19
    v_mfma_f32_16x16x32_bf16 a[36:39], a[204:207], v[172:175], a[36:39]
    v_cvt_pk_bf16_f32 v131, v234, v235
    v_mfma_f32_16x16x32_bf16 a[4:7], a[204:207], v[164:167], a[4:7]
    ds_read_b64_tr_b16 a[236:237], v241 offset:672
    ds_read_b64_tr_b16 a[238:239], v241 offset:928
    v_exp_f32 v228, v32
    v_mfma_f32_16x16x32_bf16 a[4:7], a[200:203], v[160:163], a[4:7]
    v_exp_f32 v229, v33
    s_waitcnt lgkmcnt(8)
    v_mfma_f32_16x16x32_bf16 a[8:11], a[208:211], v[160:163], a[8:11]
    v_cvt_pk_bf16_f32 v132, v228, v229
    v_mfma_f32_16x16x32_bf16 a[8:11], a[212:215], v[164:167], a[8:11]
    v_exp_f32 v230, v34
    v_mfma_f32_16x16x32_bf16 a[40:43], a[212:215], v[172:175], a[40:43]
    v_mfma_f32_16x16x32_bf16 a[40:43], a[208:211], v[168:171], a[40:43]
    v_exp_f32 v231, v35
    v_mfma_f32_16x16x32_bf16 a[72:75], a[208:211], v[176:179], a[72:75]
    v_cvt_pk_bf16_f32 v133, v230, v231
    v_mfma_f32_16x16x32_bf16 a[72:75], a[212:215], v[180:183], a[72:75]
    v_exp_f32 v232, v48
    v_mfma_f32_16x16x32_bf16 a[104:107], a[212:215], v[188:191], a[104:107]
    v_exp_f32 v233, v49
    v_mfma_f32_16x16x32_bf16 a[104:107], a[208:211], v[184:187], a[104:107]
    v_cvt_pk_bf16_f32 v134, v232, v233
    v_mfma_f32_16x16x32_bf16 a[108:111], a[216:219], v[184:187], a[108:111]
    ds_read_b64_tr_b16 a[240:241], v241 offset:192
    ds_read_b64_tr_b16 a[242:243], v241 offset:448
    v_exp_f32 v234, v50
    v_mfma_f32_16x16x32_bf16 a[108:111], a[220:223], v[188:191], a[108:111]
    v_mfma_f32_16x16x32_bf16 a[76:79], a[220:223], v[180:183], a[76:79]
    ds_read_b64_tr_b16 a[244:245], v241 offset:704
    ds_read_b64_tr_b16 a[246:247], v241 offset:960
    v_exp_f32 v235, v51
    v_mfma_f32_16x16x32_bf16 a[76:79], a[216:219], v[176:179], a[76:79]
    v_cvt_pk_bf16_f32 v135, v234, v235
    v_mfma_f32_16x16x32_bf16 a[44:47], a[216:219], v[168:171], a[44:47]
    ds_read_b64_tr_b16 a[248:249], v241 offset:224
    ds_read_b64_tr_b16 a[250:251], v241 offset:480
    v_exp_f32 v228, v4
    v_mfma_f32_16x16x32_bf16 a[44:47], a[220:223], v[172:175], a[44:47]
    v_exp_f32 v229, v5
    v_smfmac_f32_16x16x64_bf16 v[208:211], v[236:239], v[128:135], v245
    v_cvt_pk_bf16_f32 v136, v228, v229
    v_mfma_f32_16x16x32_bf16 a[12:15], a[220:223], v[164:167], a[12:15]
    ds_read_b64_tr_b16 a[252:253], v241 offset:736
    ds_read_b64_tr_b16 a[254:255], v241 offset:992
    v_mfma_f32_16x16x32_bf16 a[12:15], a[216:219], v[160:163], a[12:15]
    v_exp_f32 v230, v6
    s_waitcnt lgkmcnt(8)
    v_mfma_f32_16x16x32_bf16 a[16:19], a[224:227], v[160:163], a[16:19]
    v_mfma_f32_16x16x32_bf16 a[16:19], a[228:231], v[164:167], a[16:19]
    v_exp_f32 v231, v7
    v_mfma_f32_16x16x32_bf16 a[48:51], a[228:231], v[172:175], a[48:51]
    v_cvt_pk_bf16_f32 v137, v230, v231
    v_mfma_f32_16x16x32_bf16 a[48:51], a[224:227], v[168:171], a[48:51]
    v_exp_f32 v232, v20
    v_mfma_f32_16x16x32_bf16 a[80:83], a[224:227], v[176:179], a[80:83]
    v_exp_f32 v233, v21
    v_mfma_f32_16x16x32_bf16 a[80:83], a[228:231], v[180:183], a[80:83]
    v_cvt_pk_bf16_f32 v138, v232, v233
    v_mfma_f32_16x16x32_bf16 a[112:115], a[228:231], v[188:191], a[112:115]
    v_exp_f32 v234, v22
    v_mfma_f32_16x16x32_bf16 a[112:115], a[224:227], v[184:187], a[112:115]
    v_mfma_f32_16x16x32_bf16 a[116:119], a[232:235], v[184:187], a[116:119]
    v_exp_f32 v235, v23
    v_mfma_f32_16x16x32_bf16 a[116:119], a[236:239], v[188:191], a[116:119]
    v_cvt_pk_bf16_f32 v139, v234, v235
    v_mfma_f32_16x16x32_bf16 a[84:87], a[236:239], v[180:183], a[84:87]
    v_exp_f32 v228, v36
    v_mfma_f32_16x16x32_bf16 a[84:87], a[232:235], v[176:179], a[84:87]
    v_exp_f32 v229, v37
    v_mfma_f32_16x16x32_bf16 a[52:55], a[232:235], v[168:171], a[52:55]
    v_cvt_pk_bf16_f32 v140, v228, v229
    v_mfma_f32_16x16x32_bf16 a[52:55], a[236:239], v[172:175], a[52:55]
    v_exp_f32 v230, v38
    v_mfma_f32_16x16x32_bf16 a[20:23], a[236:239], v[164:167], a[20:23]
    v_mfma_f32_16x16x32_bf16 a[20:23], a[232:235], v[160:163], a[20:23]
    v_exp_f32 v231, v39
    s_waitcnt lgkmcnt(0)
    v_mfma_f32_16x16x32_bf16 a[24:27], a[240:243], v[160:163], a[24:27]
    v_cvt_pk_bf16_f32 v141, v230, v231
    v_mfma_f32_16x16x32_bf16 a[24:27], a[244:247], v[164:167], a[24:27]
    v_exp_f32 v232, v52
    v_mfma_f32_16x16x32_bf16 a[56:59], a[244:247], v[172:175], a[56:59]
    s_waitcnt vmcnt(8) lgkmcnt(0)
    s_barrier
    v_mfma_f32_16x16x32_bf16 a[56:59], a[240:243], v[168:171], a[56:59]
    ds_read_b128 a[192:195], v240 offset:0
    ds_read_b128 a[196:199], v240 offset:16
    s_mov_b32 s54, 81920
    s_add_u32 m0, s25, 66560
    v_exp_f32 v233, v53
    v_mfma_f32_16x16x32_bf16 a[88:91], a[240:243], v[176:179], a[88:91]
    ds_read_b128 a[200:203], v240 offset:32
    ds_read_b128 a[204:207], v240 offset:48
    buffer_load_dwordx4 v244, s[16:19], s54 offen nt lds
    s_add_u32 m0, s25, 66576
    v_cvt_pk_bf16_f32 v142, v232, v233
    v_exp_f32 v234, v54
    v_mfma_f32_16x16x32_bf16 a[88:91], a[244:247], v[180:183], a[88:91]
    v_mfma_f32_16x16x32_bf16 a[120:123], a[244:247], v[188:191], a[120:123]
    v_exp_f32 v235, v55
    v_mfma_f32_16x16x32_bf16 a[120:123], a[240:243], v[184:187], a[120:123]
    v_cvt_pk_bf16_f32 v143, v234, v235
    v_mfma_f32_16x16x32_bf16 a[124:127], a[248:251], v[184:187], a[124:127]
    ds_read_b128 a[208:211], v240 offset:256
    buffer_load_dwordx4 v244, s[16:19], s54 offen offset:1024 nt lds
    s_add_u32 m0, s25, 66592
    v_exp_f32 v228, v8
    v_mfma_f32_16x16x32_bf16 a[124:127], a[252:255], v[188:191], a[124:127]
    v_exp_f32 v229, v9
    v_smfmac_f32_16x16x64_bf16 v[212:215], v[236:239], v[136:143], v245
    v_cvt_pk_bf16_f32 v144, v228, v229
    v_mfma_f32_16x16x32_bf16 a[92:95], a[252:255], v[180:183], a[92:95]
    ds_read_b128 a[212:215], v240 offset:272
    v_mfma_f32_16x16x32_bf16 a[92:95], a[248:251], v[176:179], a[92:95]
    v_exp_f32 v230, v10
    v_mfma_f32_16x16x32_bf16 a[60:63], a[248:251], v[168:171], a[60:63]
    ds_read_b128 a[216:219], v240 offset:288
    buffer_load_dwordx4 v244, s[16:19], s54 offen offset:2048 nt lds
    s_add_u32 m0, s25, 66608
    v_mfma_f32_16x16x32_bf16 a[60:63], a[252:255], v[172:175], a[60:63]
    v_exp_f32 v231, v11
    v_mfma_f32_16x16x32_bf16 a[28:31], a[252:255], v[164:167], a[28:31]
    ds_read_b128 a[220:223], v240 offset:304
    v_cvt_pk_bf16_f32 v145, v230, v231
    v_mfma_f32_16x16x32_bf16 a[28:31], a[248:251], v[160:163], a[28:31]
    v_exp_f32 v232, v24
    s_waitcnt lgkmcnt(4)
    v_mfma_f32_16x16x32_bf16 v[64:67], a[192:195], a[128:131], v[192:195]
    buffer_load_dwordx4 v244, s[16:19], s54 offen offset:3072 nt lds
    v_exp_f32 v233, v25
    v_mfma_f32_16x16x32_bf16 v[64:67], a[196:199], a[132:135], v[64:67]
    v_cvt_pk_bf16_f32 v146, v232, v233
    v_mfma_f32_16x16x32_bf16 v[64:67], a[200:203], a[136:139], v[64:67]
    v_add_u32 v241, 33280, v243
    v_exp_f32 v234, v26
    v_mfma_f32_16x16x32_bf16 v[64:67], a[204:207], a[140:143], v[64:67]
    v_mfma_f32_16x16x32_bf16 v[68:71], a[204:207], a[156:159], v[196:199]
    v_exp_f32 v235, v27
    v_mfma_f32_16x16x32_bf16 v[68:71], a[200:203], a[152:155], v[68:71]
    v_cvt_pk_bf16_f32 v147, v234, v235
    v_mfma_f32_16x16x32_bf16 v[68:71], a[196:199], a[148:151], v[68:71]
    v_exp_f32 v228, v40
    v_mfma_f32_16x16x32_bf16 v[68:71], a[192:195], a[144:147], v[68:71]
    v_exp_f32 v229, v41
    v_mfma_f32_16x16x32_bf16 v[72:75], a[192:195], a[160:163], v[200:203]
    ds_read_b128 a[224:227], v240 offset:512
    v_cvt_pk_bf16_f32 v148, v228, v229
    v_mfma_f32_16x16x32_bf16 v[72:75], a[196:199], a[164:167], v[72:75]
    v_exp_f32 v230, v42
    v_mfma_f32_16x16x32_bf16 v[72:75], a[200:203], a[168:171], v[72:75]
    ds_read_b128 a[228:231], v240 offset:528
    v_mfma_f32_16x16x32_bf16 v[72:75], a[204:207], a[172:175], v[72:75]
    v_exp_f32 v231, v43
    v_mfma_f32_16x16x32_bf16 v[76:79], a[204:207], a[188:191], v[204:207]
    ds_read_b128 a[232:235], v240 offset:544
    v_cvt_pk_bf16_f32 v149, v230, v231
    v_mfma_f32_16x16x32_bf16 v[76:79], a[200:203], a[184:187], v[76:79]
    v_exp_f32 v232, v56
    v_mfma_f32_16x16x32_bf16 v[76:79], a[196:199], a[180:183], v[76:79]
    ds_read_b128 a[236:239], v240 offset:560
    v_exp_f32 v233, v57
    v_mfma_f32_16x16x32_bf16 v[76:79], a[192:195], a[176:179], v[76:79]
    v_cvt_pk_bf16_f32 v150, v232, v233
    s_waitcnt lgkmcnt(4)
    v_mfma_f32_16x16x32_bf16 v[92:95], a[208:211], a[176:179], v[204:207]
    v_exp_f32 v234, v58
    v_mfma_f32_16x16x32_bf16 v[92:95], a[212:215], a[180:183], v[92:95]
    v_mfma_f32_16x16x32_bf16 v[92:95], a[216:219], a[184:187], v[92:95]
    v_exp_f32 v235, v59
    v_mfma_f32_16x16x32_bf16 v[92:95], a[220:223], a[188:191], v[92:95]
    v_cvt_pk_bf16_f32 v151, v234, v235
    v_mfma_f32_16x16x32_bf16 v[88:91], a[220:223], a[172:175], v[200:203]
    v_exp_f32 v228, v12
    v_mfma_f32_16x16x32_bf16 v[88:91], a[216:219], a[168:171], v[88:91]
    v_exp_f32 v229, v13
    v_smfmac_f32_16x16x64_bf16 v[216:219], v[236:239], v[144:151], v245
    v_cvt_pk_bf16_f32 v152, v228, v229
    v_mfma_f32_16x16x32_bf16 v[88:91], a[212:215], a[164:167], v[88:91]
    v_mfma_f32_16x16x32_bf16 v[88:91], a[208:211], a[160:163], v[88:91]
    v_exp_f32 v230, v14
    v_mfma_f32_16x16x32_bf16 v[84:87], a[208:211], a[144:147], v[196:199]
    ds_read_b128 a[240:243], v240 offset:768
    v_mfma_f32_16x16x32_bf16 v[84:87], a[212:215], a[148:151], v[84:87]
    v_exp_f32 v231, v15
    v_mfma_f32_16x16x32_bf16 v[84:87], a[216:219], a[152:155], v[84:87]
    ds_read_b128 a[244:247], v240 offset:784
    v_cvt_pk_bf16_f32 v153, v230, v231
    v_mfma_f32_16x16x32_bf16 v[84:87], a[220:223], a[156:159], v[84:87]
    v_exp_f32 v232, v28
    v_mfma_f32_16x16x32_bf16 v[80:83], a[220:223], a[140:143], v[192:195]
    ds_read_b128 a[248:251], v240 offset:800
    v_exp_f32 v233, v29
    v_mfma_f32_16x16x32_bf16 v[80:83], a[216:219], a[136:139], v[80:83]
    v_cvt_pk_bf16_f32 v154, v232, v233
    v_mfma_f32_16x16x32_bf16 v[80:83], a[212:215], a[132:135], v[80:83]
    ds_read_b128 a[252:255], v240 offset:816
    v_exp_f32 v234, v30
    v_mfma_f32_16x16x32_bf16 v[80:83], a[208:211], a[128:131], v[80:83]
    s_waitcnt lgkmcnt(4)
    v_mfma_f32_16x16x32_bf16 v[96:99], a[224:227], a[128:131], v[192:195]
    v_exp_f32 v235, v31
    v_mfma_f32_16x16x32_bf16 v[96:99], a[228:231], a[132:135], v[96:99]
    v_cvt_pk_bf16_f32 v155, v234, v235
    v_mfma_f32_16x16x32_bf16 v[96:99], a[232:235], a[136:139], v[96:99]
    v_exp_f32 v228, v44
    v_mfma_f32_16x16x32_bf16 v[96:99], a[236:239], a[140:143], v[96:99]
    v_exp_f32 v229, v45
    v_mfma_f32_16x16x32_bf16 v[100:103], a[236:239], a[156:159], v[196:199]
    v_cvt_pk_bf16_f32 v156, v228, v229
    v_mfma_f32_16x16x32_bf16 v[100:103], a[232:235], a[152:155], v[100:103]
    v_exp_f32 v230, v46
    v_mfma_f32_16x16x32_bf16 v[100:103], a[228:231], a[148:151], v[100:103]
    v_mfma_f32_16x16x32_bf16 v[100:103], a[224:227], a[144:147], v[100:103]
    v_exp_f32 v231, v47
    v_mfma_f32_16x16x32_bf16 v[104:107], a[224:227], a[160:163], v[200:203]
    v_cvt_pk_bf16_f32 v157, v230, v231
    v_mfma_f32_16x16x32_bf16 v[104:107], a[228:231], a[164:167], v[104:107]
    v_exp_f32 v232, v60
    v_mfma_f32_16x16x32_bf16 v[104:107], a[232:235], a[168:171], v[104:107]
    v_exp_f32 v233, v61
    v_mfma_f32_16x16x32_bf16 v[104:107], a[236:239], a[172:175], v[104:107]
    v_cvt_pk_bf16_f32 v158, v232, v233
    v_mfma_f32_16x16x32_bf16 v[108:111], a[236:239], a[188:191], v[204:207]
    v_exp_f32 v234, v62
    v_mfma_f32_16x16x32_bf16 v[108:111], a[232:235], a[184:187], v[108:111]
    v_mfma_f32_16x16x32_bf16 v[108:111], a[228:231], a[180:183], v[108:111]
    v_exp_f32 v235, v63
    v_mfma_f32_16x16x32_bf16 v[108:111], a[224:227], a[176:179], v[108:111]
    v_cvt_pk_bf16_f32 v159, v234, v235
    s_waitcnt lgkmcnt(0)
    v_mfma_f32_16x16x32_bf16 v[124:127], a[240:243], a[176:179], v[204:207]
    v_mfma_f32_16x16x32_bf16 v[124:127], a[244:247], a[180:183], v[124:127]
    v_smfmac_f32_16x16x64_bf16 v[220:223], v[236:239], v[152:159], v245
    v_add_f32 v224, v208, v209
    v_add_f32 v225, v212, v213
    v_mfma_f32_16x16x32_bf16 v[124:127], a[248:251], a[184:187], v[124:127]
    s_waitcnt vmcnt(4) lgkmcnt(0)
    s_barrier
    v_mfma_f32_16x16x32_bf16 v[124:127], a[252:255], a[188:191], v[124:127]
    ds_read_b64_tr_b16 a[192:193], v241 offset:0
    ds_read_b64_tr_b16 a[194:195], v241 offset:256
    s_mov_b32 s54, 114688
    s_add_u32 m0, s25, 83200
    v_mfma_f32_16x16x32_bf16 v[120:123], a[252:255], a[172:175], v[200:203]
    ds_read_b64_tr_b16 a[196:197], v241 offset:512
    ds_read_b64_tr_b16 a[198:199], v241 offset:768
    buffer_load_dwordx4 v244, s[12:15], s54 offen nt lds
    s_add_u32 m0, s25, 83216
    v_mfma_f32_16x16x32_bf16 v[120:123], a[248:251], a[168:171], v[120:123]
    ds_read_b64_tr_b16 a[200:201], v241 offset:32
    ds_read_b64_tr_b16 a[202:203], v241 offset:288
    v_mfma_f32_16x16x32_bf16 v[120:123], a[244:247], a[164:167], v[120:123]
    ds_read_b64_tr_b16 a[204:205], v241 offset:544
    ds_read_b64_tr_b16 a[206:207], v241 offset:800
    v_mfma_f32_16x16x32_bf16 v[120:123], a[240:243], a[160:163], v[120:123]
    v_add_f32 v226, v216, v217
    v_max3_f32 v246, v224, v225, v226
    v_mfma_f32_16x16x32_bf16 v[116:119], a[240:243], a[144:147], v[196:199]
    ds_read_b64_tr_b16 a[208:209], v241 offset:64
    ds_read_b64_tr_b16 a[210:211], v241 offset:320
    buffer_load_dwordx4 v244, s[12:15], s54 offen offset:1024 nt lds
    s_add_u32 m0, s25, 83232
    v_mfma_f32_16x16x32_bf16 v[116:119], a[244:247], a[148:151], v[116:119]
    v_add_f32 v227, v220, v221
    v_max_f32 v246, v246, v227
    v_mfma_f32_16x16x32_bf16 v[116:119], a[248:251], a[152:155], v[116:119]
    ds_read_b64_tr_b16 a[212:213], v241 offset:576
    ds_read_b64_tr_b16 a[214:215], v241 offset:832
    v_mfma_f32_16x16x32_bf16 v[116:119], a[252:255], a[156:159], v[116:119]
    v_cmp_nge_f32 vcc, s28, v246
    v_mfma_f32_16x16x32_bf16 v[112:115], a[252:255], a[140:143], v[192:195]
    ds_read_b64_tr_b16 a[216:217], v241 offset:96
    ds_read_b64_tr_b16 a[218:219], v241 offset:352
    buffer_load_dwordx4 v244, s[12:15], s54 offen offset:2048 nt lds
    s_add_u32 m0, s25, 83248
    v_mfma_f32_16x16x32_bf16 v[112:115], a[248:251], a[136:139], v[112:115]
    v_mfma_f32_16x16x32_bf16 v[112:115], a[244:247], a[132:135], v[112:115]
    ds_read_b64_tr_b16 a[220:221], v241 offset:608
    ds_read_b64_tr_b16 a[222:223], v241 offset:864
    v_mfma_f32_16x16x32_bf16 v[112:115], a[240:243], a[128:131], v[112:115]
    s_nop 0
    buffer_load_dwordx4 v244, s[12:15], s54 offen offset:3072 nt lds
    s_add_u32 s12, s12, 32768
    s_addc_u32 s13, s13, 0
    s_mov_b32 s14, 229376
    v_subrev_u32 v242, s25, v242
    v_subrev_u32 v243, s25, v243
    s_cbranch_vccnz L_fb_r4
L_r4:
.p2align 6
L_loop:
    s_waitcnt lgkmcnt(8)
    v_mfma_f32_16x16x32_bf16 a[0:3], a[192:195], v[128:131], a[0:3]
    v_exp_f32 v228, v64
    v_mfma_f32_16x16x32_bf16 a[0:3], a[196:199], v[132:135], a[0:3]
    v_exp_f32 v229, v65
    v_mfma_f32_16x16x32_bf16 a[32:35], a[196:199], v[140:143], a[32:35]
    s_mov_b32 m0, s30
    v_cvt_pk_bf16_f32 v160, v228, v229
    v_mfma_f32_16x16x32_bf16 a[32:35], a[192:195], v[136:139], a[32:35]
    v_exp_f32 v230, v66
    v_mfma_f32_16x16x32_bf16 a[64:67], a[192:195], v[144:147], a[64:67]
    buffer_load_dwordx4 v244, s[16:19], s27 offen nt lds
    v_mfma_f32_16x16x32_bf16 a[64:67], a[196:199], v[148:151], a[64:67]
    v_exp_f32 v231, v67
    v_mfma_f32_16x16x32_bf16 a[96:99], a[196:199], v[156:159], a[96:99]
    v_add_u32 v240, s33, v242
    v_cvt_pk_bf16_f32 v161, v230, v231
    v_mfma_f32_16x16x32_bf16 a[96:99], a[192:195], v[152:155], a[96:99]
    v_exp_f32 v232, v80
    v_mfma_f32_16x16x32_bf16 a[100:103], a[200:203], v[152:155], a[100:103]
    v_exp_f32 v233, v81
    v_mfma_f32_16x16x32_bf16 a[100:103], a[204:207], v[156:159], a[100:103]
    ds_read_b64_tr_b16 a[224:225], v241 offset:128
    v_cvt_pk_bf16_f32 v162, v232, v233
    v_mfma_f32_16x16x32_bf16 a[68:71], a[204:207], v[148:151], a[68:71]
    v_exp_f32 v234, v82
    v_mfma_f32_16x16x32_bf16 a[68:71], a[200:203], v[144:147], a[68:71]
    ds_read_b64_tr_b16 a[226:227], v241 offset:384
    ds_read_b64_tr_b16 a[228:229], v241 offset:640
    v_mfma_f32_16x16x32_bf16 a[36:39], a[200:203], v[136:139], a[36:39]
    v_exp_f32 v235, v83
    v_mfma_f32_16x16x32_bf16 a[36:39], a[204:207], v[140:143], a[36:39]
    ds_read_b64_tr_b16 a[230:231], v241 offset:896
    v_cvt_pk_bf16_f32 v163, v234, v235
    v_mfma_f32_16x16x32_bf16 a[4:7], a[204:207], v[132:135], a[4:7]
    v_exp_f32 v228, v96
    v_mfma_f32_16x16x32_bf16 a[4:7], a[200:203], v[128:131], a[4:7]
    ds_read_b64_tr_b16 a[232:233], v241 offset:160
    s_waitcnt lgkmcnt(5)
    v_mfma_f32_16x16x32_bf16 a[8:11], a[208:211], v[128:131], a[8:11]
    v_exp_f32 v229, v97
    v_mfma_f32_16x16x32_bf16 a[8:11], a[212:215], v[132:135], a[8:11]
    v_exp_f32 v230, v98
    v_mfma_f32_16x16x32_bf16 a[40:43], a[212:215], v[140:143], a[40:43]
    ds_read_b64_tr_b16 a[234:235], v241 offset:416
    v_cvt_pk_bf16_f32 v164, v228, v229
    v_mfma_f32_16x16x32_bf16 a[40:43], a[208:211], v[136:139], a[40:43]
    v_exp_f32 v231, v99
    v_mfma_f32_16x16x32_bf16 a[72:75], a[208:211], v[144:147], a[72:75]
    ds_read_b64_tr_b16 a[236:237], v241 offset:672
    v_cvt_pk_bf16_f32 v165, v230, v231
    v_mfma_f32_16x16x32_bf16 a[72:75], a[212:215], v[148:151], a[72:75]
    v_exp_f32 v232, v112
    v_mfma_f32_16x16x32_bf16 a[104:107], a[212:215], v[156:159], a[104:107]
    ds_read_b64_tr_b16 a[238:239], v241 offset:928
    s_add_u32 m0, s30, 16
    v_mfma_f32_16x16x32_bf16 a[104:107], a[208:211], v[152:155], a[104:107]
    v_exp_f32 v233, v113
    v_mfma_f32_16x16x32_bf16 a[108:111], a[216:219], v[152:155], a[108:111]
    v_exp_f32 v234, v114
    v_mfma_f32_16x16x32_bf16 a[108:111], a[220:223], v[156:159], a[108:111]
    ds_read_b64_tr_b16 a[240:241], v241 offset:192
    v_cvt_pk_bf16_f32 v166, v232, v233
    v_mfma_f32_16x16x32_bf16 a[76:79], a[220:223], v[148:151], a[76:79]
    v_exp_f32 v235, v115
    v_mfma_f32_16x16x32_bf16 a[76:79], a[216:219], v[144:147], a[76:79]
    ds_read_b64_tr_b16 a[242:243], v241 offset:448
    v_cvt_pk_bf16_f32 v167, v234, v235
    v_mfma_f32_16x16x32_bf16 a[44:47], a[216:219], v[136:139], a[44:47]
    v_exp_f32 v228, v68
    v_mfma_f32_16x16x32_bf16 a[44:47], a[220:223], v[140:143], a[44:47]
    ds_read_b64_tr_b16 a[244:245], v241 offset:704
    ds_read_b64_tr_b16 a[246:247], v241 offset:960
    v_smfmac_f32_16x16x64_bf16 v[208:211], v[236:239], v[160:167], v245
    ds_read_b64_tr_b16 a[248:249], v241 offset:224
    ds_read_b64_tr_b16 a[250:251], v241 offset:480
    v_mfma_f32_16x16x32_bf16 a[12:15], a[220:223], v[132:135], a[12:15]
    v_exp_f32 v229, v69
    v_mfma_f32_16x16x32_bf16 a[12:15], a[216:219], v[128:131], a[12:15]
    v_cvt_pk_bf16_f32 v168, v228, v229
    s_waitcnt lgkmcnt(6)
    v_mfma_f32_16x16x32_bf16 a[16:19], a[224:227], v[128:131], a[16:19]
    v_exp_f32 v230, v70
    v_mfma_f32_16x16x32_bf16 a[16:19], a[228:231], v[132:135], a[16:19]
    v_exp_f32 v231, v71
    v_mfma_f32_16x16x32_bf16 a[48:51], a[228:231], v[140:143], a[48:51]
    ds_read_b64_tr_b16 a[252:253], v241 offset:736
    v_cvt_pk_bf16_f32 v169, v230, v231
    v_mfma_f32_16x16x32_bf16 a[48:51], a[224:227], v[136:139], a[48:51]
    v_exp_f32 v232, v84
    v_mfma_f32_16x16x32_bf16 a[80:83], a[224:227], v[144:147], a[80:83]
    ds_read_b64_tr_b16 a[254:255], v241 offset:992
    buffer_load_dwordx4 v244, s[16:19], s27 offen offset:1024 nt lds
    v_mfma_f32_16x16x32_bf16 a[80:83], a[228:231], v[148:151], a[80:83]
    v_exp_f32 v233, v85
    v_mfma_f32_16x16x32_bf16 a[112:115], a[228:231], v[156:159], a[112:115]
    s_add_u32 m0, s30, 32
    v_cvt_pk_bf16_f32 v170, v232, v233
    v_mfma_f32_16x16x32_bf16 a[112:115], a[224:227], v[152:155], a[112:115]
    v_exp_f32 v234, v86
    v_mfma_f32_16x16x32_bf16 a[116:119], a[232:235], v[152:155], a[116:119]
    v_exp_f32 v235, v87
    v_mfma_f32_16x16x32_bf16 a[116:119], a[236:239], v[156:159], a[116:119]
    buffer_load_dwordx4 v244, s[16:19], s27 offen offset:2048 nt lds
    v_cvt_pk_bf16_f32 v171, v234, v235
    v_mfma_f32_16x16x32_bf16 a[84:87], a[236:239], v[148:151], a[84:87]
    v_exp_f32 v228, v100
    v_mfma_f32_16x16x32_bf16 a[84:87], a[232:235], v[144:147], a[84:87]
    ds_read_b128 a[192:195], v240 offset:0
    ds_read_b128 a[196:199], v240 offset:16
    v_mfma_f32_16x16x32_bf16 a[52:55], a[232:235], v[136:139], a[52:55]
    v_exp_f32 v229, v101
    v_mfma_f32_16x16x32_bf16 a[52:55], a[236:239], v[140:143], a[52:55]
    ds_read_b128 a[200:203], v240 offset:32
    v_cvt_pk_bf16_f32 v172, v228, v229
    v_mfma_f32_16x16x32_bf16 a[20:23], a[236:239], v[132:135], a[20:23]
    v_exp_f32 v230, v102
    v_mfma_f32_16x16x32_bf16 a[20:23], a[232:235], v[128:131], a[20:23]
    ds_read_b128 a[204:207], v240 offset:48
    s_waitcnt lgkmcnt(4)
    v_mfma_f32_16x16x32_bf16 a[24:27], a[240:243], v[128:131], a[24:27]
    v_exp_f32 v231, v103
    v_mfma_f32_16x16x32_bf16 a[24:27], a[244:247], v[132:135], a[24:27]
    v_exp_f32 v232, v116
    v_mfma_f32_16x16x32_bf16 a[56:59], a[244:247], v[140:143], a[56:59]
    s_add_u32 m0, s30, 48
    v_cvt_pk_bf16_f32 v173, v230, v231
    v_mfma_f32_16x16x32_bf16 a[56:59], a[240:243], v[136:139], a[56:59]
    v_exp_f32 v233, v117
    v_mfma_f32_16x16x32_bf16 a[88:91], a[240:243], v[144:147], a[88:91]
    buffer_load_dwordx4 v244, s[16:19], s27 offen offset:3072 nt lds
    v_cvt_pk_bf16_f32 v174, v232, v233
    v_mfma_f32_16x16x32_bf16 a[88:91], a[244:247], v[148:151], a[88:91]
    v_exp_f32 v234, v118
    v_mfma_f32_16x16x32_bf16 a[120:123], a[244:247], v[156:159], a[120:123]
    s_mov_b32 m0, s31
    v_mfma_f32_16x16x32_bf16 a[120:123], a[240:243], v[152:155], a[120:123]
    v_exp_f32 v235, v119
    v_mfma_f32_16x16x32_bf16 a[124:127], a[248:251], v[152:155], a[124:127]
    ds_read_b128 a[208:211], v240 offset:256
    v_cvt_pk_bf16_f32 v175, v234, v235
    v_mfma_f32_16x16x32_bf16 a[124:127], a[252:255], v[156:159], a[124:127]
    v_exp_f32 v228, v72
    v_mfma_f32_16x16x32_bf16 a[92:95], a[252:255], v[148:151], a[92:95]
    v_exp_f32 v229, v73
    v_smfmac_f32_16x16x64_bf16 v[212:215], v[236:239], v[168:175], v245
    ds_read_b128 a[212:215], v240 offset:272
    v_cvt_pk_bf16_f32 v176, v228, v229
    v_mfma_f32_16x16x32_bf16 a[92:95], a[248:251], v[144:147], a[92:95]
    buffer_load_dwordx4 v244, s[12:15], s27 offen nt lds
    v_mfma_f32_16x16x32_bf16 a[60:63], a[248:251], v[136:139], a[60:63]
    v_exp_f32 v230, v74
    v_mfma_f32_16x16x32_bf16 a[60:63], a[252:255], v[140:143], a[60:63]
    ds_read_b128 a[216:219], v240 offset:288
    s_add_u32 m0, s31, 16
    v_mfma_f32_16x16x32_bf16 a[28:31], a[252:255], v[132:135], a[28:31]
    v_exp_f32 v231, v75
    v_mfma_f32_16x16x32_bf16 a[28:31], a[248:251], v[128:131], a[28:31]
    v_cvt_pk_bf16_f32 v177, v230, v231
    s_waitcnt lgkmcnt(3)
    v_mfma_f32_16x16x32_bf16 v[0:3], a[192:195], a[128:131], v[192:195]
    v_exp_f32 v232, v88
    v_mfma_f32_16x16x32_bf16 v[0:3], a[196:199], a[132:135], v[0:3]
    v_exp_f32 v233, v89
    v_mfma_f32_16x16x32_bf16 v[0:3], a[200:203], a[136:139], v[0:3]
    ds_read_b128 a[220:223], v240 offset:304
    v_cvt_pk_bf16_f32 v178, v232, v233
    v_mfma_f32_16x16x32_bf16 v[0:3], a[204:207], a[140:143], v[0:3]
    v_exp_f32 v234, v90
    v_mfma_f32_16x16x32_bf16 v[4:7], a[204:207], a[156:159], v[196:199]
    buffer_load_dwordx4 v244, s[12:15], s27 offen offset:1024 nt lds
    v_mfma_f32_16x16x32_bf16 v[4:7], a[200:203], a[152:155], v[4:7]
    v_exp_f32 v235, v91
    v_mfma_f32_16x16x32_bf16 v[4:7], a[196:199], a[148:151], v[4:7]
    s_add_u32 m0, s31, 32
    v_cvt_pk_bf16_f32 v179, v234, v235
    v_mfma_f32_16x16x32_bf16 v[4:7], a[192:195], a[144:147], v[4:7]
    v_exp_f32 v228, v104
    v_mfma_f32_16x16x32_bf16 v[8:11], a[192:195], a[160:163], v[200:203]
    ds_read_b128 a[224:227], v240 offset:512
    buffer_load_dwordx4 v244, s[12:15], s27 offen offset:2048 nt lds
    v_mfma_f32_16x16x32_bf16 v[8:11], a[196:199], a[164:167], v[8:11]
    v_exp_f32 v229, v105
    v_mfma_f32_16x16x32_bf16 v[8:11], a[200:203], a[168:171], v[8:11]
    v_exp_f32 v230, v106
    v_mfma_f32_16x16x32_bf16 v[8:11], a[204:207], a[172:175], v[8:11]
    ds_read_b128 a[228:231], v240 offset:528
    v_cvt_pk_bf16_f32 v180, v228, v229
    v_mfma_f32_16x16x32_bf16 v[12:15], a[204:207], a[188:191], v[204:207]
    v_exp_f32 v231, v107
    v_mfma_f32_16x16x32_bf16 v[12:15], a[200:203], a[184:187], v[12:15]
    ds_read_b128 a[232:235], v240 offset:544
    v_cvt_pk_bf16_f32 v181, v230, v231
    v_mfma_f32_16x16x32_bf16 v[12:15], a[196:199], a[180:183], v[12:15]
    v_exp_f32 v232, v120
    v_mfma_f32_16x16x32_bf16 v[12:15], a[192:195], a[176:179], v[12:15]
    ds_read_b128 a[236:239], v240 offset:560
    s_waitcnt lgkmcnt(4)
    v_mfma_f32_16x16x32_bf16 v[28:31], a[208:211], a[176:179], v[204:207]
    v_exp_f32 v233, v121
    v_mfma_f32_16x16x32_bf16 v[28:31], a[212:215], a[180:183], v[28:31]
    v_exp_f32 v234, v122
    v_mfma_f32_16x16x32_bf16 v[28:31], a[216:219], a[184:187], v[28:31]
    s_add_u32 s30, s33, 16640
    v_cvt_pk_bf16_f32 v182, v232, v233
    v_mfma_f32_16x16x32_bf16 v[28:31], a[220:223], a[188:191], v[28:31]
    v_exp_f32 v235, v123
    v_mfma_f32_16x16x32_bf16 v[24:27], a[220:223], a[172:175], v[200:203]
    s_cmp_lt_u32 s30, s26
    v_cvt_pk_bf16_f32 v183, v234, v235
    v_mfma_f32_16x16x32_bf16 v[24:27], a[216:219], a[168:171], v[24:27]
    v_exp_f32 v228, v76
    v_mfma_f32_16x16x32_bf16 v[24:27], a[212:215], a[164:167], v[24:27]
    s_cselect_b32 s30, s30, s25
    v_smfmac_f32_16x16x64_bf16 v[216:219], v[236:239], v[176:183], v245
    v_add_u32 v241, s30, v243
    v_mfma_f32_16x16x32_bf16 v[24:27], a[208:211], a[160:163], v[24:27]
    v_exp_f32 v229, v77
    v_mfma_f32_16x16x32_bf16 v[20:23], a[208:211], a[144:147], v[196:199]
    s_add_u32 m0, s31, 48
    v_cvt_pk_bf16_f32 v184, v228, v229
    v_mfma_f32_16x16x32_bf16 v[20:23], a[212:215], a[148:151], v[20:23]
    v_exp_f32 v230, v78
    v_mfma_f32_16x16x32_bf16 v[20:23], a[216:219], a[152:155], v[20:23]
    v_exp_f32 v231, v79
    v_mfma_f32_16x16x32_bf16 v[20:23], a[220:223], a[156:159], v[20:23]
    buffer_load_dwordx4 v244, s[12:15], s27 offen offset:3072 nt lds
    v_cvt_pk_bf16_f32 v185, v230, v231
    v_mfma_f32_16x16x32_bf16 v[16:19], a[220:223], a[140:143], v[192:195]
    v_exp_f32 v232, v92
    v_mfma_f32_16x16x32_bf16 v[16:19], a[216:219], a[136:139], v[16:19]
    ds_read_b128 a[240:243], v240 offset:768
    ds_read_b128 a[244:247], v240 offset:784
    v_mfma_f32_16x16x32_bf16 v[16:19], a[212:215], a[132:135], v[16:19]
    v_exp_f32 v233, v93
    v_mfma_f32_16x16x32_bf16 v[16:19], a[208:211], a[128:131], v[16:19]
    v_cvt_pk_bf16_f32 v186, v232, v233
    s_waitcnt lgkmcnt(2)
    v_mfma_f32_16x16x32_bf16 v[32:35], a[224:227], a[128:131], v[192:195]
    v_exp_f32 v234, v94
    v_mfma_f32_16x16x32_bf16 v[32:35], a[228:231], a[132:135], v[32:35]
    v_exp_f32 v235, v95
    v_mfma_f32_16x16x32_bf16 v[32:35], a[232:235], a[136:139], v[32:35]
    ds_read_b128 a[248:251], v240 offset:800
    v_cvt_pk_bf16_f32 v187, v234, v235
    v_mfma_f32_16x16x32_bf16 v[32:35], a[236:239], a[140:143], v[32:35]
    v_exp_f32 v228, v108
    v_mfma_f32_16x16x32_bf16 v[36:39], a[236:239], a[156:159], v[196:199]
    ds_read_b128 a[252:255], v240 offset:816
    s_add_u32 s31, s30, 16640
    v_mfma_f32_16x16x32_bf16 v[36:39], a[232:235], a[152:155], v[36:39]
    v_exp_f32 v229, v109
    v_mfma_f32_16x16x32_bf16 v[36:39], a[228:231], a[148:151], v[36:39]
    s_cmp_lt_u32 s31, s26
    v_cvt_pk_bf16_f32 v188, v228, v229
    v_mfma_f32_16x16x32_bf16 v[36:39], a[224:227], a[144:147], v[36:39]
    v_exp_f32 v230, v110
    v_mfma_f32_16x16x32_bf16 v[40:43], a[224:227], a[160:163], v[200:203]
    s_cselect_b32 s31, s31, s25
    v_mfma_f32_16x16x32_bf16 v[40:43], a[228:231], a[164:167], v[40:43]
    v_exp_f32 v231, v111
    v_mfma_f32_16x16x32_bf16 v[40:43], a[232:235], a[168:171], v[40:43]
    v_exp_f32 v232, v124
    v_mfma_f32_16x16x32_bf16 v[40:43], a[236:239], a[172:175], v[40:43]
    s_waitcnt vmcnt(8) lgkmcnt(0)
    s_barrier
    v_mfma_f32_16x16x32_bf16 v[44:47], a[236:239], a[188:191], v[204:207]
    v_exp_f32 v233, v125
    v_mfma_f32_16x16x32_bf16 v[44:47], a[232:235], a[184:187], v[44:47]
    ds_read_b64_tr_b16 a[192:193], v241 offset:0
    v_cvt_pk_bf16_f32 v189, v230, v231
    v_mfma_f32_16x16x32_bf16 v[44:47], a[228:231], a[180:183], v[44:47]
    v_exp_f32 v234, v126
    v_mfma_f32_16x16x32_bf16 v[44:47], a[224:227], a[176:179], v[44:47]
    ds_read_b64_tr_b16 a[194:195], v241 offset:256
    v_cvt_pk_bf16_f32 v190, v232, v233
    v_mfma_f32_16x16x32_bf16 v[60:63], a[240:243], a[176:179], v[204:207]
    v_exp_f32 v235, v127
    v_mfma_f32_16x16x32_bf16 v[60:63], a[244:247], a[180:183], v[60:63]
    ds_read_b64_tr_b16 a[196:197], v241 offset:512
    v_cvt_pk_bf16_f32 v191, v234, v235
    v_mfma_f32_16x16x32_bf16 v[60:63], a[248:251], a[184:187], v[60:63]
    ds_read_b64_tr_b16 a[198:199], v241 offset:768
    ds_read_b64_tr_b16 a[200:201], v241 offset:32
    v_mfma_f32_16x16x32_bf16 v[60:63], a[252:255], a[188:191], v[60:63]
    ds_read_b64_tr_b16 a[202:203], v241 offset:288
    ds_read_b64_tr_b16 a[204:205], v241 offset:544
    v_smfmac_f32_16x16x64_bf16 v[220:223], v[236:239], v[184:191], v245
    ds_read_b64_tr_b16 a[206:207], v241 offset:800
    s_add_u32 s27, s27, 0x4000
    v_mfma_f32_16x16x32_bf16 v[56:59], a[252:255], a[172:175], v[200:203]
    v_add_f32 v248, v208, v209
    v_add_f32 v249, v212, v213
    v_mfma_f32_16x16x32_bf16 v[56:59], a[248:251], a[168:171], v[56:59]
    v_add_f32 v250, v216, v217
    v_max3_f32 v246, v248, v249, v250
    v_mfma_f32_16x16x32_bf16 v[56:59], a[244:247], a[164:167], v[56:59]
    v_mfma_f32_16x16x32_bf16 v[56:59], a[240:243], a[160:163], v[56:59]
    v_mfma_f32_16x16x32_bf16 v[52:55], a[240:243], a[144:147], v[196:199]
    ds_read_b64_tr_b16 a[208:209], v241 offset:64
    ds_read_b64_tr_b16 a[210:211], v241 offset:320
    v_mfma_f32_16x16x32_bf16 v[52:55], a[244:247], a[148:151], v[52:55]
    v_add_f32 v251, v220, v221
    v_max_f32 v246, v246, v251
    v_mfma_f32_16x16x32_bf16 v[52:55], a[248:251], a[152:155], v[52:55]
    ds_read_b64_tr_b16 a[212:213], v241 offset:576
    ds_read_b64_tr_b16 a[214:215], v241 offset:832
    v_mfma_f32_16x16x32_bf16 v[52:55], a[252:255], a[156:159], v[52:55]
    v_cmp_nge_f32 vcc, s28, v246
    v_mfma_f32_16x16x32_bf16 v[48:51], a[252:255], a[140:143], v[192:195]
    ds_read_b64_tr_b16 a[216:217], v241 offset:96
    ds_read_b64_tr_b16 a[218:219], v241 offset:352
    v_mfma_f32_16x16x32_bf16 v[48:51], a[248:251], a[136:139], v[48:51]
    v_mfma_f32_16x16x32_bf16 v[48:51], a[244:247], a[132:135], v[48:51]
    ds_read_b64_tr_b16 a[220:221], v241 offset:608
    ds_read_b64_tr_b16 a[222:223], v241 offset:864
    v_mfma_f32_16x16x32_bf16 v[48:51], a[240:243], a[128:131], v[48:51]
    s_cbranch_vccnz L_fb_ret1
L_ret1:
    s_waitcnt lgkmcnt(8)
    v_mfma_f32_16x16x32_bf16 a[0:3], a[192:195], v[160:163], a[0:3]
    v_exp_f32 v228, v0
    v_mfma_f32_16x16x32_bf16 a[0:3], a[196:199], v[164:167], a[0:3]
    v_exp_f32 v229, v1
    v_mfma_f32_16x16x32_bf16 a[32:35], a[196:199], v[172:175], a[32:35]
    s_mov_b32 m0, s32
    v_cvt_pk_bf16_f32 v128, v228, v229
    v_mfma_f32_16x16x32_bf16 a[32:35], a[192:195], v[168:171], a[32:35]
    v_exp_f32 v230, v2
    v_mfma_f32_16x16x32_bf16 a[64:67], a[192:195], v[176:179], a[64:67]
    buffer_load_dwordx4 v244, s[16:19], s27 offen nt lds
    v_mfma_f32_16x16x32_bf16 a[64:67], a[196:199], v[180:183], a[64:67]
    v_exp_f32 v231, v3
    v_mfma_f32_16x16x32_bf16 a[96:99], a[196:199], v[188:191], a[96:99]
    v_add_u32 v240, s31, v242
    v_cvt_pk_bf16_f32 v129, v230, v231
    v_mfma_f32_16x16x32_bf16 a[96:99], a[192:195], v[184:187], a[96:99]
    v_exp_f32 v232, v16
    v_mfma_f32_16x16x32_bf16 a[100:103], a[200:203], v[184:187], a[100:103]
    v_exp_f32 v233, v17
    v_mfma_f32_16x16x32_bf16 a[100:103], a[204:207], v[188:191], a[100:103]
    ds_read_b64_tr_b16 a[224:225], v241 offset:128
    v_cvt_pk_bf16_f32 v130, v232, v233
    v_mfma_f32_16x16x32_bf16 a[68:71], a[204:207], v[180:183], a[68:71]
    v_exp_f32 v234, v18
    v_mfma_f32_16x16x32_bf16 a[68:71], a[200:203], v[176:179], a[68:71]
    ds_read_b64_tr_b16 a[226:227], v241 offset:384
    ds_read_b64_tr_b16 a[228:229], v241 offset:640
    v_mfma_f32_16x16x32_bf16 a[36:39], a[200:203], v[168:171], a[36:39]
    v_exp_f32 v235, v19
    v_mfma_f32_16x16x32_bf16 a[36:39], a[204:207], v[172:175], a[36:39]
    ds_read_b64_tr_b16 a[230:231], v241 offset:896
    v_cvt_pk_bf16_f32 v131, v234, v235
    v_mfma_f32_16x16x32_bf16 a[4:7], a[204:207], v[164:167], a[4:7]
    v_exp_f32 v228, v32
    v_mfma_f32_16x16x32_bf16 a[4:7], a[200:203], v[160:163], a[4:7]
    ds_read_b64_tr_b16 a[232:233], v241 offset:160
    s_waitcnt lgkmcnt(5)
    v_mfma_f32_16x16x32_bf16 a[8:11], a[208:211], v[160:163], a[8:11]
    v_exp_f32 v229, v33
    v_mfma_f32_16x16x32_bf16 a[8:11], a[212:215], v[164:167], a[8:11]
    v_exp_f32 v230, v34
    v_mfma_f32_16x16x32_bf16 a[40:43], a[212:215], v[172:175], a[40:43]
    ds_read_b64_tr_b16 a[234:235], v241 offset:416
    v_cvt_pk_bf16_f32 v132, v228, v229
    v_mfma_f32_16x16x32_bf16 a[40:43], a[208:211], v[168:171], a[40:43]
    v_exp_f32 v231, v35
    v_mfma_f32_16x16x32_bf16 a[72:75], a[208:211], v[176:179], a[72:75]
    ds_read_b64_tr_b16 a[236:237], v241 offset:672
    v_cvt_pk_bf16_f32 v133, v230, v231
    v_mfma_f32_16x16x32_bf16 a[72:75], a[212:215], v[180:183], a[72:75]
    v_exp_f32 v232, v48
    v_mfma_f32_16x16x32_bf16 a[104:107], a[212:215], v[188:191], a[104:107]
    ds_read_b64_tr_b16 a[238:239], v241 offset:928
    s_add_u32 m0, s32, 16
    v_mfma_f32_16x16x32_bf16 a[104:107], a[208:211], v[184:187], a[104:107]
    v_exp_f32 v233, v49
    v_mfma_f32_16x16x32_bf16 a[108:111], a[216:219], v[184:187], a[108:111]
    v_exp_f32 v234, v50
    v_mfma_f32_16x16x32_bf16 a[108:111], a[220:223], v[188:191], a[108:111]
    ds_read_b64_tr_b16 a[240:241], v241 offset:192
    v_cvt_pk_bf16_f32 v134, v232, v233
    v_mfma_f32_16x16x32_bf16 a[76:79], a[220:223], v[180:183], a[76:79]
    v_exp_f32 v235, v51
    v_mfma_f32_16x16x32_bf16 a[76:79], a[216:219], v[176:179], a[76:79]
    ds_read_b64_tr_b16 a[242:243], v241 offset:448
    v_cvt_pk_bf16_f32 v135, v234, v235
    v_mfma_f32_16x16x32_bf16 a[44:47], a[216:219], v[168:171], a[44:47]
    v_exp_f32 v228, v4
    v_mfma_f32_16x16x32_bf16 a[44:47], a[220:223], v[172:175], a[44:47]
    ds_read_b64_tr_b16 a[244:245], v241 offset:704
    ds_read_b64_tr_b16 a[246:247], v241 offset:960
    v_smfmac_f32_16x16x64_bf16 v[208:211], v[236:239], v[128:135], v245
    ds_read_b64_tr_b16 a[248:249], v241 offset:224
    ds_read_b64_tr_b16 a[250:251], v241 offset:480
    v_mfma_f32_16x16x32_bf16 a[12:15], a[220:223], v[164:167], a[12:15]
    v_exp_f32 v229, v5
    v_mfma_f32_16x16x32_bf16 a[12:15], a[216:219], v[160:163], a[12:15]
    v_cvt_pk_bf16_f32 v136, v228, v229
    s_waitcnt lgkmcnt(6)
    v_mfma_f32_16x16x32_bf16 a[16:19], a[224:227], v[160:163], a[16:19]
    v_exp_f32 v230, v6
    v_mfma_f32_16x16x32_bf16 a[16:19], a[228:231], v[164:167], a[16:19]
    v_exp_f32 v231, v7
    v_mfma_f32_16x16x32_bf16 a[48:51], a[228:231], v[172:175], a[48:51]
    ds_read_b64_tr_b16 a[252:253], v241 offset:736
    v_cvt_pk_bf16_f32 v137, v230, v231
    v_mfma_f32_16x16x32_bf16 a[48:51], a[224:227], v[168:171], a[48:51]
    v_exp_f32 v232, v20
    v_mfma_f32_16x16x32_bf16 a[80:83], a[224:227], v[176:179], a[80:83]
    ds_read_b64_tr_b16 a[254:255], v241 offset:992
    buffer_load_dwordx4 v244, s[16:19], s27 offen offset:1024 nt lds
    v_mfma_f32_16x16x32_bf16 a[80:83], a[228:231], v[180:183], a[80:83]
    v_exp_f32 v233, v21
    v_mfma_f32_16x16x32_bf16 a[112:115], a[228:231], v[188:191], a[112:115]
    s_add_u32 m0, s32, 32
    v_cvt_pk_bf16_f32 v138, v232, v233
    v_mfma_f32_16x16x32_bf16 a[112:115], a[224:227], v[184:187], a[112:115]
    v_exp_f32 v234, v22
    v_mfma_f32_16x16x32_bf16 a[116:119], a[232:235], v[184:187], a[116:119]
    v_exp_f32 v235, v23
    v_mfma_f32_16x16x32_bf16 a[116:119], a[236:239], v[188:191], a[116:119]
    buffer_load_dwordx4 v244, s[16:19], s27 offen offset:2048 nt lds
    v_cvt_pk_bf16_f32 v139, v234, v235
    v_mfma_f32_16x16x32_bf16 a[84:87], a[236:239], v[180:183], a[84:87]
    v_exp_f32 v228, v36
    v_mfma_f32_16x16x32_bf16 a[84:87], a[232:235], v[176:179], a[84:87]
    ds_read_b128 a[192:195], v240 offset:0
    ds_read_b128 a[196:199], v240 offset:16
    v_mfma_f32_16x16x32_bf16 a[52:55], a[232:235], v[168:171], a[52:55]
    v_exp_f32 v229, v37
    v_mfma_f32_16x16x32_bf16 a[52:55], a[236:239], v[172:175], a[52:55]
    ds_read_b128 a[200:203], v240 offset:32
    v_cvt_pk_bf16_f32 v140, v228, v229
    v_mfma_f32_16x16x32_bf16 a[20:23], a[236:239], v[164:167], a[20:23]
    v_exp_f32 v230, v38
    v_mfma_f32_16x16x32_bf16 a[20:23], a[232:235], v[160:163], a[20:23]
    ds_read_b128 a[204:207], v240 offset:48
    s_waitcnt lgkmcnt(4)
    v_mfma_f32_16x16x32_bf16 a[24:27], a[240:243], v[160:163], a[24:27]
    v_exp_f32 v231, v39
    v_mfma_f32_16x16x32_bf16 a[24:27], a[244:247], v[164:167], a[24:27]
    v_exp_f32 v232, v52
    v_mfma_f32_16x16x32_bf16 a[56:59], a[244:247], v[172:175], a[56:59]
    s_add_u32 m0, s32, 48
    v_cvt_pk_bf16_f32 v141, v230, v231
    v_mfma_f32_16x16x32_bf16 a[56:59], a[240:243], v[168:171], a[56:59]
    v_exp_f32 v233, v53
    v_mfma_f32_16x16x32_bf16 a[88:91], a[240:243], v[176:179], a[88:91]
    buffer_load_dwordx4 v244, s[16:19], s27 offen offset:3072 nt lds
    v_cvt_pk_bf16_f32 v142, v232, v233
    v_mfma_f32_16x16x32_bf16 a[88:91], a[244:247], v[180:183], a[88:91]
    v_exp_f32 v234, v54
    v_mfma_f32_16x16x32_bf16 a[120:123], a[244:247], v[188:191], a[120:123]
    s_mov_b32 m0, s33
    v_mfma_f32_16x16x32_bf16 a[120:123], a[240:243], v[184:187], a[120:123]
    v_exp_f32 v235, v55
    v_mfma_f32_16x16x32_bf16 a[124:127], a[248:251], v[184:187], a[124:127]
    ds_read_b128 a[208:211], v240 offset:256
    v_cvt_pk_bf16_f32 v143, v234, v235
    v_mfma_f32_16x16x32_bf16 a[124:127], a[252:255], v[188:191], a[124:127]
    v_exp_f32 v228, v8
    v_mfma_f32_16x16x32_bf16 a[92:95], a[252:255], v[180:183], a[92:95]
    v_exp_f32 v229, v9
    v_smfmac_f32_16x16x64_bf16 v[212:215], v[236:239], v[136:143], v245
    ds_read_b128 a[212:215], v240 offset:272
    v_cvt_pk_bf16_f32 v144, v228, v229
    v_mfma_f32_16x16x32_bf16 a[92:95], a[248:251], v[176:179], a[92:95]
    buffer_load_dwordx4 v244, s[12:15], s27 offen nt lds
    v_mfma_f32_16x16x32_bf16 a[60:63], a[248:251], v[168:171], a[60:63]
    v_exp_f32 v230, v10
    v_mfma_f32_16x16x32_bf16 a[60:63], a[252:255], v[172:175], a[60:63]
    ds_read_b128 a[216:219], v240 offset:288
    s_add_u32 m0, s33, 16
    v_mfma_f32_16x16x32_bf16 a[28:31], a[252:255], v[164:167], a[28:31]
    v_exp_f32 v231, v11
    v_mfma_f32_16x16x32_bf16 a[28:31], a[248:251], v[160:163], a[28:31]
    v_cvt_pk_bf16_f32 v145, v230, v231
    s_waitcnt lgkmcnt(3)
    v_mfma_f32_16x16x32_bf16 v[64:67], a[192:195], a[128:131], v[192:195]
    v_exp_f32 v232, v24
    v_mfma_f32_16x16x32_bf16 v[64:67], a[196:199], a[132:135], v[64:67]
    v_exp_f32 v233, v25
    v_mfma_f32_16x16x32_bf16 v[64:67], a[200:203], a[136:139], v[64:67]
    ds_read_b128 a[220:223], v240 offset:304
    v_cvt_pk_bf16_f32 v146, v232, v233
    v_mfma_f32_16x16x32_bf16 v[64:67], a[204:207], a[140:143], v[64:67]
    v_exp_f32 v234, v26
    v_mfma_f32_16x16x32_bf16 v[68:71], a[204:207], a[156:159], v[196:199]
    buffer_load_dwordx4 v244, s[12:15], s27 offen offset:1024 nt lds
    v_mfma_f32_16x16x32_bf16 v[68:71], a[200:203], a[152:155], v[68:71]
    v_exp_f32 v235, v27
    v_mfma_f32_16x16x32_bf16 v[68:71], a[196:199], a[148:151], v[68:71]
    s_add_u32 m0, s33, 32
    v_cvt_pk_bf16_f32 v147, v234, v235
    v_mfma_f32_16x16x32_bf16 v[68:71], a[192:195], a[144:147], v[68:71]
    v_exp_f32 v228, v40
    v_mfma_f32_16x16x32_bf16 v[72:75], a[192:195], a[160:163], v[200:203]
    ds_read_b128 a[224:227], v240 offset:512
    buffer_load_dwordx4 v244, s[12:15], s27 offen offset:2048 nt lds
    v_mfma_f32_16x16x32_bf16 v[72:75], a[196:199], a[164:167], v[72:75]
    v_exp_f32 v229, v41
    v_mfma_f32_16x16x32_bf16 v[72:75], a[200:203], a[168:171], v[72:75]
    v_exp_f32 v230, v42
    v_mfma_f32_16x16x32_bf16 v[72:75], a[204:207], a[172:175], v[72:75]
    ds_read_b128 a[228:231], v240 offset:528
    v_cvt_pk_bf16_f32 v148, v228, v229
    v_mfma_f32_16x16x32_bf16 v[76:79], a[204:207], a[188:191], v[204:207]
    v_exp_f32 v231, v43
    v_mfma_f32_16x16x32_bf16 v[76:79], a[200:203], a[184:187], v[76:79]
    ds_read_b128 a[232:235], v240 offset:544
    v_cvt_pk_bf16_f32 v149, v230, v231
    v_mfma_f32_16x16x32_bf16 v[76:79], a[196:199], a[180:183], v[76:79]
    v_exp_f32 v232, v56
    v_mfma_f32_16x16x32_bf16 v[76:79], a[192:195], a[176:179], v[76:79]
    ds_read_b128 a[236:239], v240 offset:560
    s_waitcnt lgkmcnt(4)
    v_mfma_f32_16x16x32_bf16 v[92:95], a[208:211], a[176:179], v[204:207]
    v_exp_f32 v233, v57
    v_mfma_f32_16x16x32_bf16 v[92:95], a[212:215], a[180:183], v[92:95]
    v_exp_f32 v234, v58
    v_mfma_f32_16x16x32_bf16 v[92:95], a[216:219], a[184:187], v[92:95]
    s_add_u32 s32, s31, 16640
    v_cvt_pk_bf16_f32 v150, v232, v233
    v_mfma_f32_16x16x32_bf16 v[92:95], a[220:223], a[188:191], v[92:95]
    v_exp_f32 v235, v59
    v_mfma_f32_16x16x32_bf16 v[88:91], a[220:223], a[172:175], v[200:203]
    s_cmp_lt_u32 s32, s26
    v_cvt_pk_bf16_f32 v151, v234, v235
    v_mfma_f32_16x16x32_bf16 v[88:91], a[216:219], a[168:171], v[88:91]
    v_exp_f32 v228, v12
    v_mfma_f32_16x16x32_bf16 v[88:91], a[212:215], a[164:167], v[88:91]
    s_cselect_b32 s32, s32, s25
    v_smfmac_f32_16x16x64_bf16 v[216:219], v[236:239], v[144:151], v245
    v_add_u32 v241, s32, v243
    v_mfma_f32_16x16x32_bf16 v[88:91], a[208:211], a[160:163], v[88:91]
    v_exp_f32 v229, v13
    v_mfma_f32_16x16x32_bf16 v[84:87], a[208:211], a[144:147], v[196:199]
    s_add_u32 m0, s33, 48
    v_cvt_pk_bf16_f32 v152, v228, v229
    v_mfma_f32_16x16x32_bf16 v[84:87], a[212:215], a[148:151], v[84:87]
    v_exp_f32 v230, v14
    v_mfma_f32_16x16x32_bf16 v[84:87], a[216:219], a[152:155], v[84:87]
    v_exp_f32 v231, v15
    v_mfma_f32_16x16x32_bf16 v[84:87], a[220:223], a[156:159], v[84:87]
    buffer_load_dwordx4 v244, s[12:15], s27 offen offset:3072 nt lds
    v_cvt_pk_bf16_f32 v153, v230, v231
    v_mfma_f32_16x16x32_bf16 v[80:83], a[220:223], a[140:143], v[192:195]
    v_exp_f32 v232, v28
    v_mfma_f32_16x16x32_bf16 v[80:83], a[216:219], a[136:139], v[80:83]
    ds_read_b128 a[240:243], v240 offset:768
    ds_read_b128 a[244:247], v240 offset:784
    v_mfma_f32_16x16x32_bf16 v[80:83], a[212:215], a[132:135], v[80:83]
    v_exp_f32 v233, v29
    v_mfma_f32_16x16x32_bf16 v[80:83], a[208:211], a[128:131], v[80:83]
    v_cvt_pk_bf16_f32 v154, v232, v233
    s_waitcnt lgkmcnt(2)
    v_mfma_f32_16x16x32_bf16 v[96:99], a[224:227], a[128:131], v[192:195]
    v_exp_f32 v234, v30
    v_mfma_f32_16x16x32_bf16 v[96:99], a[228:231], a[132:135], v[96:99]
    v_exp_f32 v235, v31
    v_mfma_f32_16x16x32_bf16 v[96:99], a[232:235], a[136:139], v[96:99]
    ds_read_b128 a[248:251], v240 offset:800
    v_cvt_pk_bf16_f32 v155, v234, v235
    v_mfma_f32_16x16x32_bf16 v[96:99], a[236:239], a[140:143], v[96:99]
    v_exp_f32 v228, v44
    v_mfma_f32_16x16x32_bf16 v[100:103], a[236:239], a[156:159], v[196:199]
    ds_read_b128 a[252:255], v240 offset:816
    s_add_u32 s33, s32, 16640
    v_mfma_f32_16x16x32_bf16 v[100:103], a[232:235], a[152:155], v[100:103]
    v_exp_f32 v229, v45
    v_mfma_f32_16x16x32_bf16 v[100:103], a[228:231], a[148:151], v[100:103]
    s_cmp_lt_u32 s33, s26
    v_cvt_pk_bf16_f32 v156, v228, v229
    v_mfma_f32_16x16x32_bf16 v[100:103], a[224:227], a[144:147], v[100:103]
    v_exp_f32 v230, v46
    v_mfma_f32_16x16x32_bf16 v[104:107], a[224:227], a[160:163], v[200:203]
    s_cselect_b32 s33, s33, s25
    v_mfma_f32_16x16x32_bf16 v[104:107], a[228:231], a[164:167], v[104:107]
    v_exp_f32 v231, v47
    v_mfma_f32_16x16x32_bf16 v[104:107], a[232:235], a[168:171], v[104:107]
    v_exp_f32 v232, v60
    v_mfma_f32_16x16x32_bf16 v[104:107], a[236:239], a[172:175], v[104:107]
    s_waitcnt vmcnt(8) lgkmcnt(0)
    s_barrier
    v_mfma_f32_16x16x32_bf16 v[108:111], a[236:239], a[188:191], v[204:207]
    v_exp_f32 v233, v61
    v_mfma_f32_16x16x32_bf16 v[108:111], a[232:235], a[184:187], v[108:111]
    ds_read_b64_tr_b16 a[192:193], v241 offset:0
    v_cvt_pk_bf16_f32 v157, v230, v231
    v_mfma_f32_16x16x32_bf16 v[108:111], a[228:231], a[180:183], v[108:111]
    v_exp_f32 v234, v62
    v_mfma_f32_16x16x32_bf16 v[108:111], a[224:227], a[176:179], v[108:111]
    ds_read_b64_tr_b16 a[194:195], v241 offset:256
    v_cvt_pk_bf16_f32 v158, v232, v233
    v_mfma_f32_16x16x32_bf16 v[124:127], a[240:243], a[176:179], v[204:207]
    v_exp_f32 v235, v63
    v_mfma_f32_16x16x32_bf16 v[124:127], a[244:247], a[180:183], v[124:127]
    ds_read_b64_tr_b16 a[196:197], v241 offset:512
    v_cvt_pk_bf16_f32 v159, v234, v235
    v_mfma_f32_16x16x32_bf16 v[124:127], a[248:251], a[184:187], v[124:127]
    ds_read_b64_tr_b16 a[198:199], v241 offset:768
    ds_read_b64_tr_b16 a[200:201], v241 offset:32
    v_mfma_f32_16x16x32_bf16 v[124:127], a[252:255], a[188:191], v[124:127]
    ds_read_b64_tr_b16 a[202:203], v241 offset:288
    ds_read_b64_tr_b16 a[204:205], v241 offset:544
    v_smfmac_f32_16x16x64_bf16 v[220:223], v[236:239], v[152:159], v245
    ds_read_b64_tr_b16 a[206:207], v241 offset:800
    s_add_u32 s27, s27, 0x4000
    v_mfma_f32_16x16x32_bf16 v[120:123], a[252:255], a[172:175], v[200:203]
    v_add_f32 v224, v208, v209
    v_add_f32 v225, v212, v213
    v_mfma_f32_16x16x32_bf16 v[120:123], a[248:251], a[168:171], v[120:123]
    v_add_f32 v226, v216, v217
    v_max3_f32 v246, v224, v225, v226
    v_mfma_f32_16x16x32_bf16 v[120:123], a[244:247], a[164:167], v[120:123]
    v_mfma_f32_16x16x32_bf16 v[120:123], a[240:243], a[160:163], v[120:123]
    v_mfma_f32_16x16x32_bf16 v[116:119], a[240:243], a[144:147], v[196:199]
    ds_read_b64_tr_b16 a[208:209], v241 offset:64
    ds_read_b64_tr_b16 a[210:211], v241 offset:320
    v_mfma_f32_16x16x32_bf16 v[116:119], a[244:247], a[148:151], v[116:119]
    v_add_f32 v227, v220, v221
    v_max_f32 v246, v246, v227
    v_mfma_f32_16x16x32_bf16 v[116:119], a[248:251], a[152:155], v[116:119]
    ds_read_b64_tr_b16 a[212:213], v241 offset:576
    ds_read_b64_tr_b16 a[214:215], v241 offset:832
    v_mfma_f32_16x16x32_bf16 v[116:119], a[252:255], a[156:159], v[116:119]
    v_cmp_nge_f32 vcc, s28, v246
    v_mfma_f32_16x16x32_bf16 v[112:115], a[252:255], a[140:143], v[192:195]
    ds_read_b64_tr_b16 a[216:217], v241 offset:96
    ds_read_b64_tr_b16 a[218:219], v241 offset:352
    v_mfma_f32_16x16x32_bf16 v[112:115], a[248:251], a[136:139], v[112:115]
    v_mfma_f32_16x16x32_bf16 v[112:115], a[244:247], a[132:135], v[112:115]
    ds_read_b64_tr_b16 a[220:221], v241 offset:608
    ds_read_b64_tr_b16 a[222:223], v241 offset:864
    v_mfma_f32_16x16x32_bf16 v[112:115], a[240:243], a[128:131], v[112:115]
    s_cbranch_vccnz L_fb_ret2
L_ret2:
    s_cmp_lt_u32 s27, 262144
    s_cbranch_scc1 L_loop
    s_waitcnt lgkmcnt(8)
    v_mfma_f32_16x16x32_bf16 a[0:3], a[192:195], v[128:131], a[0:3]
    v_add_u32 v240, s25, v243
    v_exp_f32 v228, v64
    v_exp_f32 v229, v65
    v_mfma_f32_16x16x32_bf16 a[0:3], a[196:199], v[132:135], a[0:3]
    s_mul_i32 s50, s24, 17408
    v_cvt_pk_bf16_f32 v160, v228, v229
    v_exp_f32 v230, v66
    v_mfma_f32_16x16x32_bf16 a[32:35], a[196:199], v[140:143], a[32:35]
    s_add_u32 s50, s50, 16640
    v_exp_f32 v231, v67
    v_mfma_f32_16x16x32_bf16 a[32:35], a[192:195], v[136:139], a[32:35]
    s_mul_i32 s52, s24, 12288
    v_cvt_pk_bf16_f32 v161, v230, v231
    v_exp_f32 v232, v80
    v_mfma_f32_16x16x32_bf16 a[64:67], a[192:195], v[144:147], a[64:67]
    v_bfe_u32 v247, v244, 4, 4
    v_exp_f32 v233, v81
    v_mfma_f32_16x16x32_bf16 a[64:67], a[196:199], v[148:151], a[64:67]
    v_mul_u32_u24 v242, 272, v247
    v_cvt_pk_bf16_f32 v162, v232, v233
    v_exp_f32 v234, v82
    v_exp_f32 v235, v83
    v_mfma_f32_16x16x32_bf16 a[96:99], a[196:199], v[156:159], a[96:99]
    v_bfe_u32 v243, v244, 8, 2
    v_cvt_pk_bf16_f32 v163, v234, v235
    v_exp_f32 v228, v96
    v_mfma_f32_16x16x32_bf16 a[96:99], a[192:195], v[152:155], a[96:99]
    v_lshl_add_u32 v242, v243, 3, v242
    v_exp_f32 v229, v97
    v_mfma_f32_16x16x32_bf16 a[100:103], a[200:203], v[152:155], a[100:103]
    ds_read_b64_tr_b16 a[224:225], v241 offset:128
    ds_read_b64_tr_b16 a[226:227], v241 offset:384
    v_add_u32 v242, s50, v242
    v_cvt_pk_bf16_f32 v164, v228, v229
    v_exp_f32 v230, v98
    v_mfma_f32_16x16x32_bf16 a[100:103], a[204:207], v[156:159], a[100:103]
    v_mul_u32_u24 v243, 272, v243
    v_exp_f32 v231, v99
    v_mfma_f32_16x16x32_bf16 a[68:71], a[204:207], v[148:151], a[68:71]
    ds_read_b64_tr_b16 a[228:229], v241 offset:640
    ds_read_b64_tr_b16 a[230:231], v241 offset:896
    v_lshl_add_u32 v243, v247, 4, v243
    v_cvt_pk_bf16_f32 v165, v230, v231
    v_exp_f32 v232, v112
    v_exp_f32 v233, v113
    v_mfma_f32_16x16x32_bf16 a[68:71], a[200:203], v[144:147], a[68:71]
    v_add_u32 v243, s50, v243
    v_cvt_pk_bf16_f32 v166, v232, v233
    v_exp_f32 v234, v114
    v_mfma_f32_16x16x32_bf16 a[36:39], a[200:203], v[136:139], a[36:39]
    ds_read_b64_tr_b16 a[232:233], v241 offset:160
    ds_read_b64_tr_b16 a[234:235], v241 offset:416
    v_exp_f32 v235, v115
    v_mfma_f32_16x16x32_bf16 a[36:39], a[204:207], v[140:143], a[36:39]
    v_cvt_pk_bf16_f32 v167, v234, v235
    v_exp_f32 v228, v68
    v_mfma_f32_16x16x32_bf16 a[4:7], a[204:207], v[132:135], a[4:7]
    ds_read_b64_tr_b16 a[236:237], v241 offset:672
    ds_read_b64_tr_b16 a[238:239], v241 offset:928
    v_exp_f32 v229, v69
    v_mfma_f32_16x16x32_bf16 a[4:7], a[200:203], v[128:131], a[4:7]
    v_cvt_pk_bf16_f32 v168, v228, v229
    v_exp_f32 v230, v70
    v_smfmac_f32_16x16x64_bf16 v[208:211], v[236:239], v[160:167], v245
    s_waitcnt lgkmcnt(8)
    v_mfma_f32_16x16x32_bf16 a[8:11], a[208:211], v[128:131], a[8:11]
    v_exp_f32 v231, v71
    v_exp_f32 v232, v84
    v_mfma_f32_16x16x32_bf16 a[8:11], a[212:215], v[132:135], a[8:11]
    v_cvt_pk_bf16_f32 v169, v230, v231
    v_exp_f32 v233, v85
    v_mfma_f32_16x16x32_bf16 a[40:43], a[212:215], v[140:143], a[40:43]
    v_cvt_pk_bf16_f32 v170, v232, v233
    v_exp_f32 v234, v86
    v_mfma_f32_16x16x32_bf16 a[40:43], a[208:211], v[136:139], a[40:43]
    v_exp_f32 v235, v87
    v_mfma_f32_16x16x32_bf16 a[72:75], a[208:211], v[144:147], a[72:75]
    v_cvt_pk_bf16_f32 v171, v234, v235
    v_exp_f32 v228, v100
    v_mfma_f32_16x16x32_bf16 a[72:75], a[212:215], v[148:151], a[72:75]
    v_exp_f32 v229, v101
    v_exp_f32 v230, v102
    v_mfma_f32_16x16x32_bf16 a[104:107], a[212:215], v[156:159], a[104:107]
    v_cvt_pk_bf16_f32 v172, v228, v229
    v_exp_f32 v231, v103
    v_mfma_f32_16x16x32_bf16 a[104:107], a[208:211], v[152:155], a[104:107]
    v_cvt_pk_bf16_f32 v173, v230, v231
    v_exp_f32 v232, v116
    v_mfma_f32_16x16x32_bf16 a[108:111], a[216:219], v[152:155], a[108:111]
    ds_read_b64_tr_b16 a[240:241], v241 offset:192
    ds_read_b64_tr_b16 a[242:243], v241 offset:448
    v_exp_f32 v233, v117
    v_mfma_f32_16x16x32_bf16 a[108:111], a[220:223], v[156:159], a[108:111]
    v_cvt_pk_bf16_f32 v174, v232, v233
    v_exp_f32 v234, v118
    v_mfma_f32_16x16x32_bf16 a[76:79], a[220:223], v[148:151], a[76:79]
    ds_read_b64_tr_b16 a[244:245], v241 offset:704
    ds_read_b64_tr_b16 a[246:247], v241 offset:960
    v_exp_f32 v235, v119
    v_mfma_f32_16x16x32_bf16 a[76:79], a[216:219], v[144:147], a[76:79]
    v_cvt_pk_bf16_f32 v175, v234, v235
    v_exp_f32 v228, v72
    v_exp_f32 v229, v73
    v_mfma_f32_16x16x32_bf16 a[44:47], a[216:219], v[136:139], a[44:47]
    ds_read_b64_tr_b16 a[248:249], v241 offset:224
    ds_read_b64_tr_b16 a[250:251], v241 offset:480
    v_cvt_pk_bf16_f32 v176, v228, v229
    v_exp_f32 v230, v74
    v_mfma_f32_16x16x32_bf16 a[44:47], a[220:223], v[140:143], a[44:47]
    v_exp_f32 v231, v75
    v_smfmac_f32_16x16x64_bf16 v[212:215], v[236:239], v[168:175], v245
    v_cvt_pk_bf16_f32 v177, v230, v231
    v_mfma_f32_16x16x32_bf16 a[12:15], a[220:223], v[132:135], a[12:15]
    ds_read_b64_tr_b16 a[252:253], v241 offset:736
    ds_read_b64_tr_b16 a[254:255], v241 offset:992
    v_exp_f32 v232, v88
    v_mfma_f32_16x16x32_bf16 a[12:15], a[216:219], v[128:131], a[12:15]
    v_exp_f32 v233, v89
    s_waitcnt lgkmcnt(8)
    v_mfma_f32_16x16x32_bf16 a[16:19], a[224:227], v[128:131], a[16:19]
    v_cvt_pk_bf16_f32 v178, v232, v233
    v_exp_f32 v234, v90
    v_exp_f32 v235, v91
    v_mfma_f32_16x16x32_bf16 a[16:19], a[228:231], v[132:135], a[16:19]
    v_cvt_pk_bf16_f32 v179, v234, v235
    v_exp_f32 v228, v104
    v_mfma_f32_16x16x32_bf16 a[48:51], a[228:231], v[140:143], a[48:51]
    v_exp_f32 v229, v105
    v_mfma_f32_16x16x32_bf16 a[48:51], a[224:227], v[136:139], a[48:51]
    v_cvt_pk_bf16_f32 v180, v228, v229
    v_exp_f32 v230, v106
    v_mfma_f32_16x16x32_bf16 a[80:83], a[224:227], v[144:147], a[80:83]
    v_exp_f32 v231, v107
    v_mfma_f32_16x16x32_bf16 a[80:83], a[228:231], v[148:151], a[80:83]
    v_cvt_pk_bf16_f32 v181, v230, v231
    v_exp_f32 v232, v120
    v_exp_f32 v233, v121
    v_mfma_f32_16x16x32_bf16 a[112:115], a[228:231], v[156:159], a[112:115]
    v_cvt_pk_bf16_f32 v182, v232, v233
    v_exp_f32 v234, v122
    v_mfma_f32_16x16x32_bf16 a[112:115], a[224:227], v[152:155], a[112:115]
    v_exp_f32 v235, v123
    v_mfma_f32_16x16x32_bf16 a[116:119], a[232:235], v[152:155], a[116:119]
    v_cvt_pk_bf16_f32 v183, v234, v235
    v_exp_f32 v228, v76
    v_mfma_f32_16x16x32_bf16 a[116:119], a[236:239], v[156:159], a[116:119]
    v_exp_f32 v229, v77
    v_mfma_f32_16x16x32_bf16 a[84:87], a[236:239], v[148:151], a[84:87]
    v_cvt_pk_bf16_f32 v184, v228, v229
    v_exp_f32 v230, v78
    v_smfmac_f32_16x16x64_bf16 v[216:219], v[236:239], v[176:183], v245
    v_mfma_f32_16x16x32_bf16 a[84:87], a[232:235], v[144:147], a[84:87]
    s_waitcnt vmcnt(0) lgkmcnt(0)
    s_barrier
    v_mfma_f32_16x16x32_bf16 a[52:55], a[232:235], v[136:139], a[52:55]
    ds_read_b64_tr_b16 a[128:129], v240 offset:0
    ds_read_b64_tr_b16 a[130:131], v240 offset:256
    v_exp_f32 v231, v79
    v_exp_f32 v232, v92
    v_exp_f32 v233, v93
    v_mfma_f32_16x16x32_bf16 a[52:55], a[236:239], v[140:143], a[52:55]
    ds_read_b64_tr_b16 a[132:133], v240 offset:512
    ds_read_b64_tr_b16 a[134:135], v240 offset:768
    v_cvt_pk_bf16_f32 v185, v230, v231
    v_cvt_pk_bf16_f32 v186, v232, v233
    v_exp_f32 v234, v94
    v_mfma_f32_16x16x32_bf16 a[20:23], a[236:239], v[132:135], a[20:23]
    ds_read_b64_tr_b16 a[136:137], v240 offset:32
    ds_read_b64_tr_b16 a[138:139], v240 offset:288
    v_exp_f32 v235, v95
    v_mfma_f32_16x16x32_bf16 a[20:23], a[232:235], v[128:131], a[20:23]
    ds_read_b64_tr_b16 a[140:141], v240 offset:544
    ds_read_b64_tr_b16 a[142:143], v240 offset:800
    v_cvt_pk_bf16_f32 v187, v234, v235
    v_exp_f32 v228, v108
    v_mfma_f32_16x16x32_bf16 a[24:27], a[240:243], v[128:131], a[24:27]
    ds_read_b64_tr_b16 a[144:145], v240 offset:64
    ds_read_b64_tr_b16 a[146:147], v240 offset:320
    v_exp_f32 v229, v109
    v_exp_f32 v230, v110
    v_mfma_f32_16x16x32_bf16 a[24:27], a[244:247], v[132:135], a[24:27]
    ds_read_b64_tr_b16 a[148:149], v240 offset:576
    ds_read_b64_tr_b16 a[150:151], v240 offset:832
    v_cvt_pk_bf16_f32 v188, v228, v229
    v_exp_f32 v231, v111
    v_mfma_f32_16x16x32_bf16 a[56:59], a[244:247], v[140:143], a[56:59]
    ds_read_b64_tr_b16 a[152:153], v240 offset:96
    ds_read_b64_tr_b16 a[154:155], v240 offset:352
    v_cvt_pk_bf16_f32 v189, v230, v231
    v_exp_f32 v232, v124
    v_mfma_f32_16x16x32_bf16 a[56:59], a[240:243], v[136:139], a[56:59]
    ds_read_b64_tr_b16 a[156:157], v240 offset:608
    ds_read_b64_tr_b16 a[158:159], v240 offset:864
    v_exp_f32 v233, v125
    v_mfma_f32_16x16x32_bf16 a[88:91], a[240:243], v[144:147], a[88:91]
    ds_read_b64_tr_b16 a[160:161], v240 offset:128
    ds_read_b64_tr_b16 a[162:163], v240 offset:384
    v_cvt_pk_bf16_f32 v190, v232, v233
    v_exp_f32 v234, v126
    v_mfma_f32_16x16x32_bf16 a[88:91], a[244:247], v[148:151], a[88:91]
    ds_read_b64_tr_b16 a[164:165], v240 offset:640
    ds_read_b64_tr_b16 a[166:167], v240 offset:896
    v_exp_f32 v235, v127
    v_mfma_f32_16x16x32_bf16 a[120:123], a[244:247], v[156:159], a[120:123]
    ds_read_b64_tr_b16 a[168:169], v240 offset:160
    ds_read_b64_tr_b16 a[170:171], v240 offset:416
    v_cvt_pk_bf16_f32 v191, v234, v235
    v_mfma_f32_16x16x32_bf16 a[120:123], a[240:243], v[152:155], a[120:123]
    ds_read_b64_tr_b16 a[172:173], v240 offset:672
    ds_read_b64_tr_b16 a[174:175], v240 offset:928
    v_mfma_f32_16x16x32_bf16 a[124:127], a[248:251], v[152:155], a[124:127]
    ds_read_b64_tr_b16 a[176:177], v240 offset:192
    ds_read_b64_tr_b16 a[178:179], v240 offset:448
    v_smfmac_f32_16x16x64_bf16 v[220:223], v[236:239], v[184:191], v245
    v_add_f32 v248, v208, v209
    v_add_f32 v249, v212, v213
    v_mfma_f32_16x16x32_bf16 a[124:127], a[252:255], v[156:159], a[124:127]
    ds_read_b64_tr_b16 a[180:181], v240 offset:704
    ds_read_b64_tr_b16 a[182:183], v240 offset:960
    v_mfma_f32_16x16x32_bf16 a[92:95], a[252:255], v[148:151], a[92:95]
    ds_read_b64_tr_b16 a[184:185], v240 offset:224
    ds_read_b64_tr_b16 a[186:187], v240 offset:480
    v_mfma_f32_16x16x32_bf16 a[92:95], a[248:251], v[144:147], a[92:95]
    ds_read_b64_tr_b16 a[188:189], v240 offset:736
    ds_read_b64_tr_b16 a[190:191], v240 offset:992
    v_mfma_f32_16x16x32_bf16 a[60:63], a[248:251], v[136:139], a[60:63]
    v_add_f32 v250, v216, v217
    v_max3_f32 v246, v248, v249, v250
    v_mfma_f32_16x16x32_bf16 a[60:63], a[252:255], v[140:143], a[60:63]
    v_add_f32 v251, v220, v221
    v_max_f32 v246, v246, v251
    v_mfma_f32_16x16x32_bf16 a[28:31], a[252:255], v[132:135], a[28:31]
    v_cmp_nge_f32 vcc, s28, v246
    v_mfma_f32_16x16x32_bf16 a[28:31], a[248:251], v[128:131], a[28:31]
    s_cbranch_vccnz L_fb_ret3
L_ret3:
    s_waitcnt lgkmcnt(15)
    v_mfma_f32_16x16x32_bf16 a[0:3], a[128:131], v[160:163], a[0:3]
    v_mfma_f32_16x16x32_bf16 a[0:3], a[132:135], v[164:167], a[0:3]
    v_rcp_f32 v228, v248
    v_rcp_f32 v230, v249
    v_rcp_f32 v232, v250
    v_rcp_f32 v234, v251
    v_mfma_f32_16x16x32_bf16 a[4:7], a[136:139], v[160:163], a[4:7]
    v_mfma_f32_16x16x32_bf16 a[4:7], a[140:143], v[164:167], a[4:7]
    s_waitcnt lgkmcnt(15)
    v_mfma_f32_16x16x32_bf16 a[8:11], a[144:147], v[160:163], a[8:11]
    v_accvgpr_read_b32 v0, a0
    v_accvgpr_read_b32 v1, a1
    v_accvgpr_read_b32 v2, a2
    v_accvgpr_read_b32 v3, a3
    v_mul_f32 v0, v0, v228
    v_mfma_f32_16x16x32_bf16 a[8:11], a[148:151], v[164:167], a[8:11]
    v_mul_f32 v1, v1, v228
    v_mul_f32 v2, v2, v228
    v_mul_f32 v3, v3, v228
    v_cvt_pk_bf16_f32 v0, v0, v1
    v_cvt_pk_bf16_f32 v1, v2, v3
    v_mfma_f32_16x16x32_bf16 a[12:15], a[152:155], v[160:163], a[12:15]
    ds_write_b64 v242, v[0:1] offset:0
    v_accvgpr_read_b32 v4, a4
    v_accvgpr_read_b32 v5, a5
    v_accvgpr_read_b32 v6, a6
    v_accvgpr_read_b32 v7, a7
    v_mul_f32 v4, v4, v228
    v_mfma_f32_16x16x32_bf16 a[12:15], a[156:159], v[164:167], a[12:15]
    v_mul_f32 v5, v5, v228
    v_mul_f32 v6, v6, v228
    v_mul_f32 v7, v7, v228
    v_cvt_pk_bf16_f32 v4, v4, v5
    v_cvt_pk_bf16_f32 v5, v6, v7
    s_waitcnt lgkmcnt(9)
    v_mfma_f32_16x16x32_bf16 a[16:19], a[160:163], v[160:163], a[16:19]
    ds_write_b64 v242, v[4:5] offset:32
    v_accvgpr_read_b32 v8, a8
    v_accvgpr_read_b32 v9, a9
    v_accvgpr_read_b32 v10, a10
    v_accvgpr_read_b32 v11, a11
    v_mul_f32 v8, v8, v228
    v_mfma_f32_16x16x32_bf16 a[16:19], a[164:167], v[164:167], a[16:19]
    v_mul_f32 v9, v9, v228
    v_mul_f32 v10, v10, v228
    v_mul_f32 v11, v11, v228
    v_cvt_pk_bf16_f32 v8, v8, v9
    v_cvt_pk_bf16_f32 v9, v10, v11
    v_mfma_f32_16x16x32_bf16 a[20:23], a[168:171], v[160:163], a[20:23]
    ds_write_b64 v242, v[8:9] offset:64
    v_accvgpr_read_b32 v12, a12
    v_accvgpr_read_b32 v13, a13
    v_accvgpr_read_b32 v14, a14
    v_accvgpr_read_b32 v15, a15
    v_mul_f32 v12, v12, v228
    v_mfma_f32_16x16x32_bf16 a[20:23], a[172:175], v[164:167], a[20:23]
    v_mul_f32 v13, v13, v228
    v_mul_f32 v14, v14, v228
    v_mul_f32 v15, v15, v228
    v_cvt_pk_bf16_f32 v12, v12, v13
    v_cvt_pk_bf16_f32 v13, v14, v15
    s_waitcnt lgkmcnt(3)
    v_mfma_f32_16x16x32_bf16 a[24:27], a[176:179], v[160:163], a[24:27]
    ds_write_b64 v242, v[12:13] offset:96
    v_accvgpr_read_b32 v16, a16
    v_accvgpr_read_b32 v17, a17
    v_accvgpr_read_b32 v18, a18
    v_accvgpr_read_b32 v19, a19
    v_mul_f32 v16, v16, v228
    v_mfma_f32_16x16x32_bf16 a[24:27], a[180:183], v[164:167], a[24:27]
    v_mul_f32 v17, v17, v228
    v_mul_f32 v18, v18, v228
    v_mul_f32 v19, v19, v228
    v_cvt_pk_bf16_f32 v16, v16, v17
    v_cvt_pk_bf16_f32 v17, v18, v19
    v_mfma_f32_16x16x32_bf16 a[28:31], a[184:187], v[160:163], a[28:31]
    ds_write_b64 v242, v[16:17] offset:128
    v_accvgpr_read_b32 v20, a20
    v_accvgpr_read_b32 v21, a21
    v_accvgpr_read_b32 v22, a22
    v_accvgpr_read_b32 v23, a23
    v_mul_f32 v20, v20, v228
    v_mfma_f32_16x16x32_bf16 a[28:31], a[188:191], v[164:167], a[28:31]
    v_mul_f32 v21, v21, v228
    v_mul_f32 v22, v22, v228
    v_mul_f32 v23, v23, v228
    v_cvt_pk_bf16_f32 v20, v20, v21
    v_cvt_pk_bf16_f32 v21, v22, v23
    v_mfma_f32_16x16x32_bf16 a[32:35], a[128:131], v[168:171], a[32:35]
    ds_write_b64 v242, v[20:21] offset:160
    v_accvgpr_read_b32 v24, a24
    v_accvgpr_read_b32 v25, a25
    v_accvgpr_read_b32 v26, a26
    v_accvgpr_read_b32 v27, a27
    v_mul_f32 v24, v24, v228
    v_mfma_f32_16x16x32_bf16 a[32:35], a[132:135], v[172:175], a[32:35]
    v_mul_f32 v25, v25, v228
    v_mul_f32 v26, v26, v228
    v_mul_f32 v27, v27, v228
    v_cvt_pk_bf16_f32 v24, v24, v25
    v_cvt_pk_bf16_f32 v25, v26, v27
    v_mfma_f32_16x16x32_bf16 a[36:39], a[136:139], v[168:171], a[36:39]
    ds_write_b64 v242, v[24:25] offset:192
    v_accvgpr_read_b32 v28, a28
    v_accvgpr_read_b32 v29, a29
    v_accvgpr_read_b32 v30, a30
    v_accvgpr_read_b32 v31, a31
    v_mul_f32 v28, v28, v228
    v_mfma_f32_16x16x32_bf16 a[36:39], a[140:143], v[172:175], a[36:39]
    v_mul_f32 v29, v29, v228
    v_mul_f32 v30, v30, v228
    v_mul_f32 v31, v31, v228
    v_cvt_pk_bf16_f32 v28, v28, v29
    v_cvt_pk_bf16_f32 v29, v30, v31
    v_mfma_f32_16x16x32_bf16 a[40:43], a[144:147], v[168:171], a[40:43]
    ds_write_b64 v242, v[28:29] offset:224
    ds_read_b128 v[64:67], v243 offset:0
    v_accvgpr_read_b32 v0, a32
    v_accvgpr_read_b32 v1, a33
    v_accvgpr_read_b32 v2, a34
    v_accvgpr_read_b32 v3, a35
    v_mul_f32 v0, v0, v230
    v_mfma_f32_16x16x32_bf16 a[40:43], a[148:151], v[172:175], a[40:43]
    ds_read_b128 v[68:71], v243 offset:1088
    ds_read_b128 v[72:75], v243 offset:2176
    v_mul_f32 v1, v1, v230
    v_mul_f32 v2, v2, v230
    v_mul_f32 v3, v3, v230
    v_cvt_pk_bf16_f32 v0, v0, v1
    v_cvt_pk_bf16_f32 v1, v2, v3
    v_mfma_f32_16x16x32_bf16 a[44:47], a[152:155], v[168:171], a[44:47]
    ds_read_b128 v[76:79], v243 offset:3264
    ds_write_b64 v242, v[0:1] offset:4352
    v_accvgpr_read_b32 v4, a36
    v_accvgpr_read_b32 v5, a37
    v_accvgpr_read_b32 v6, a38
    v_accvgpr_read_b32 v7, a39
    v_mul_f32 v4, v4, v230
    v_mfma_f32_16x16x32_bf16 a[44:47], a[156:159], v[172:175], a[44:47]
    v_mul_f32 v5, v5, v230
    v_mul_f32 v6, v6, v230
    v_mul_f32 v7, v7, v230
    v_cvt_pk_bf16_f32 v4, v4, v5
    v_cvt_pk_bf16_f32 v5, v6, v7
    v_mfma_f32_16x16x32_bf16 a[48:51], a[160:163], v[168:171], a[48:51]
    ds_write_b64 v242, v[4:5] offset:4384
    s_waitcnt lgkmcnt(2)
    buffer_store_dwordx4 v[64:67], v244, s[20:23], s52 offen offset:0 nt
    v_accvgpr_read_b32 v8, a40
    v_accvgpr_read_b32 v9, a41
    v_accvgpr_read_b32 v10, a42
    v_accvgpr_read_b32 v11, a43
    v_mul_f32 v8, v8, v230
    v_mfma_f32_16x16x32_bf16 a[48:51], a[164:167], v[172:175], a[48:51]
    v_mul_f32 v9, v9, v230
    v_mul_f32 v10, v10, v230
    v_mul_f32 v11, v11, v230
    v_cvt_pk_bf16_f32 v8, v8, v9
    v_cvt_pk_bf16_f32 v9, v10, v11
    v_mfma_f32_16x16x32_bf16 a[52:55], a[168:171], v[168:171], a[52:55]
    ds_write_b64 v242, v[8:9] offset:4416
    v_accvgpr_read_b32 v12, a44
    v_accvgpr_read_b32 v13, a45
    v_accvgpr_read_b32 v14, a46
    v_accvgpr_read_b32 v15, a47
    v_mul_f32 v12, v12, v230
    v_mfma_f32_16x16x32_bf16 a[52:55], a[172:175], v[172:175], a[52:55]
    buffer_store_dwordx4 v[68:71], v244, s[20:23], s52 offen offset:1024 nt
    v_mul_f32 v13, v13, v230
    v_mul_f32 v14, v14, v230
    v_mul_f32 v15, v15, v230
    v_cvt_pk_bf16_f32 v12, v12, v13
    v_cvt_pk_bf16_f32 v13, v14, v15
    v_mfma_f32_16x16x32_bf16 a[56:59], a[176:179], v[168:171], a[56:59]
    ds_write_b64 v242, v[12:13] offset:4448
    v_accvgpr_read_b32 v16, a48
    v_accvgpr_read_b32 v17, a49
    v_accvgpr_read_b32 v18, a50
    v_accvgpr_read_b32 v19, a51
    v_mul_f32 v16, v16, v230
    v_mfma_f32_16x16x32_bf16 a[56:59], a[180:183], v[172:175], a[56:59]
    v_mul_f32 v17, v17, v230
    v_mul_f32 v18, v18, v230
    v_mul_f32 v19, v19, v230
    v_cvt_pk_bf16_f32 v16, v16, v17
    v_cvt_pk_bf16_f32 v17, v18, v19
    v_mfma_f32_16x16x32_bf16 a[60:63], a[184:187], v[168:171], a[60:63]
    ds_write_b64 v242, v[16:17] offset:4480
    buffer_store_dwordx4 v[72:75], v244, s[20:23], s52 offen offset:2048 nt
    v_accvgpr_read_b32 v20, a52
    v_accvgpr_read_b32 v21, a53
    v_accvgpr_read_b32 v22, a54
    v_accvgpr_read_b32 v23, a55
    v_mul_f32 v20, v20, v230
    v_mfma_f32_16x16x32_bf16 a[60:63], a[188:191], v[172:175], a[60:63]
    v_mul_f32 v21, v21, v230
    v_mul_f32 v22, v22, v230
    v_mul_f32 v23, v23, v230
    v_cvt_pk_bf16_f32 v20, v20, v21
    v_cvt_pk_bf16_f32 v21, v22, v23
    v_mfma_f32_16x16x32_bf16 a[64:67], a[128:131], v[176:179], a[64:67]
    ds_write_b64 v242, v[20:21] offset:4512
    v_accvgpr_read_b32 v24, a56
    v_accvgpr_read_b32 v25, a57
    v_accvgpr_read_b32 v26, a58
    v_accvgpr_read_b32 v27, a59
    v_mul_f32 v24, v24, v230
    v_mfma_f32_16x16x32_bf16 a[64:67], a[132:135], v[180:183], a[64:67]
    buffer_store_dwordx4 v[76:79], v244, s[20:23], s52 offen offset:3072 nt
    s_add_u32 s52, s52, 4096
    v_mul_f32 v25, v25, v230
    v_mul_f32 v26, v26, v230
    v_mul_f32 v27, v27, v230
    v_cvt_pk_bf16_f32 v24, v24, v25
    v_cvt_pk_bf16_f32 v25, v26, v27
    v_mfma_f32_16x16x32_bf16 a[68:71], a[136:139], v[176:179], a[68:71]
    ds_write_b64 v242, v[24:25] offset:4544
    v_accvgpr_read_b32 v28, a60
    v_accvgpr_read_b32 v29, a61
    v_accvgpr_read_b32 v30, a62
    v_accvgpr_read_b32 v31, a63
    v_mul_f32 v28, v28, v230
    v_mfma_f32_16x16x32_bf16 a[68:71], a[140:143], v[180:183], a[68:71]
    v_mul_f32 v29, v29, v230
    v_mul_f32 v30, v30, v230
    v_mul_f32 v31, v31, v230
    v_cvt_pk_bf16_f32 v28, v28, v29
    v_cvt_pk_bf16_f32 v29, v30, v31
    v_mfma_f32_16x16x32_bf16 a[72:75], a[144:147], v[176:179], a[72:75]
    ds_write_b64 v242, v[28:29] offset:4576
    ds_read_b128 v[80:83], v243 offset:4352
    v_accvgpr_read_b32 v0, a64
    v_accvgpr_read_b32 v1, a65
    v_accvgpr_read_b32 v2, a66
    v_accvgpr_read_b32 v3, a67
    v_mul_f32 v0, v0, v232
    v_mfma_f32_16x16x32_bf16 a[72:75], a[148:151], v[180:183], a[72:75]
    ds_read_b128 v[84:87], v243 offset:5440
    ds_read_b128 v[88:91], v243 offset:6528
    v_mul_f32 v1, v1, v232
    v_mul_f32 v2, v2, v232
    v_mul_f32 v3, v3, v232
    v_cvt_pk_bf16_f32 v0, v0, v1
    v_cvt_pk_bf16_f32 v1, v2, v3
    v_mfma_f32_16x16x32_bf16 a[76:79], a[152:155], v[176:179], a[76:79]
    ds_read_b128 v[92:95], v243 offset:7616
    ds_write_b64 v242, v[0:1] offset:8704
    v_accvgpr_read_b32 v4, a68
    v_accvgpr_read_b32 v5, a69
    v_accvgpr_read_b32 v6, a70
    v_accvgpr_read_b32 v7, a71
    v_mul_f32 v4, v4, v232
    v_mfma_f32_16x16x32_bf16 a[76:79], a[156:159], v[180:183], a[76:79]
    v_mul_f32 v5, v5, v232
    v_mul_f32 v6, v6, v232
    v_mul_f32 v7, v7, v232
    v_cvt_pk_bf16_f32 v4, v4, v5
    v_cvt_pk_bf16_f32 v5, v6, v7
    v_mfma_f32_16x16x32_bf16 a[80:83], a[160:163], v[176:179], a[80:83]
    ds_write_b64 v242, v[4:5] offset:8736
    s_waitcnt lgkmcnt(2)
    buffer_store_dwordx4 v[80:83], v244, s[20:23], s52 offen offset:0 nt
    v_accvgpr_read_b32 v8, a72
    v_accvgpr_read_b32 v9, a73
    v_accvgpr_read_b32 v10, a74
    v_accvgpr_read_b32 v11, a75
    v_mul_f32 v8, v8, v232
    v_mfma_f32_16x16x32_bf16 a[80:83], a[164:167], v[180:183], a[80:83]
    v_mul_f32 v9, v9, v232
    v_mul_f32 v10, v10, v232
    v_mul_f32 v11, v11, v232
    v_cvt_pk_bf16_f32 v8, v8, v9
    v_cvt_pk_bf16_f32 v9, v10, v11
    v_mfma_f32_16x16x32_bf16 a[84:87], a[168:171], v[176:179], a[84:87]
    ds_write_b64 v242, v[8:9] offset:8768
    v_accvgpr_read_b32 v12, a76
    v_accvgpr_read_b32 v13, a77
    v_accvgpr_read_b32 v14, a78
    v_accvgpr_read_b32 v15, a79
    v_mul_f32 v12, v12, v232
    v_mfma_f32_16x16x32_bf16 a[84:87], a[172:175], v[180:183], a[84:87]
    buffer_store_dwordx4 v[84:87], v244, s[20:23], s52 offen offset:1024 nt
    v_mul_f32 v13, v13, v232
    v_mul_f32 v14, v14, v232
    v_mul_f32 v15, v15, v232
    v_cvt_pk_bf16_f32 v12, v12, v13
    v_cvt_pk_bf16_f32 v13, v14, v15
    v_mfma_f32_16x16x32_bf16 a[88:91], a[176:179], v[176:179], a[88:91]
    ds_write_b64 v242, v[12:13] offset:8800
    v_accvgpr_read_b32 v16, a80
    v_accvgpr_read_b32 v17, a81
    v_accvgpr_read_b32 v18, a82
    v_accvgpr_read_b32 v19, a83
    v_mul_f32 v16, v16, v232
    v_mfma_f32_16x16x32_bf16 a[88:91], a[180:183], v[180:183], a[88:91]
    v_mul_f32 v17, v17, v232
    v_mul_f32 v18, v18, v232
    v_mul_f32 v19, v19, v232
    v_cvt_pk_bf16_f32 v16, v16, v17
    v_cvt_pk_bf16_f32 v17, v18, v19
    v_mfma_f32_16x16x32_bf16 a[92:95], a[184:187], v[176:179], a[92:95]
    ds_write_b64 v242, v[16:17] offset:8832
    buffer_store_dwordx4 v[88:91], v244, s[20:23], s52 offen offset:2048 nt
    v_accvgpr_read_b32 v20, a84
    v_accvgpr_read_b32 v21, a85
    v_accvgpr_read_b32 v22, a86
    v_accvgpr_read_b32 v23, a87
    v_mul_f32 v20, v20, v232
    v_mfma_f32_16x16x32_bf16 a[92:95], a[188:191], v[180:183], a[92:95]
    v_mul_f32 v21, v21, v232
    v_mul_f32 v22, v22, v232
    v_mul_f32 v23, v23, v232
    v_cvt_pk_bf16_f32 v20, v20, v21
    v_cvt_pk_bf16_f32 v21, v22, v23
    v_mfma_f32_16x16x32_bf16 a[96:99], a[128:131], v[184:187], a[96:99]
    ds_write_b64 v242, v[20:21] offset:8864
    v_accvgpr_read_b32 v24, a88
    v_accvgpr_read_b32 v25, a89
    v_accvgpr_read_b32 v26, a90
    v_accvgpr_read_b32 v27, a91
    v_mul_f32 v24, v24, v232
    v_mfma_f32_16x16x32_bf16 a[96:99], a[132:135], v[188:191], a[96:99]
    buffer_store_dwordx4 v[92:95], v244, s[20:23], s52 offen offset:3072 nt
    s_add_u32 s52, s52, 4096
    v_mul_f32 v25, v25, v232
    v_mul_f32 v26, v26, v232
    v_mul_f32 v27, v27, v232
    v_cvt_pk_bf16_f32 v24, v24, v25
    v_cvt_pk_bf16_f32 v25, v26, v27
    v_mfma_f32_16x16x32_bf16 a[100:103], a[136:139], v[184:187], a[100:103]
    ds_write_b64 v242, v[24:25] offset:8896
    v_accvgpr_read_b32 v28, a92
    v_accvgpr_read_b32 v29, a93
    v_accvgpr_read_b32 v30, a94
    v_accvgpr_read_b32 v31, a95
    v_mul_f32 v28, v28, v232
    v_mfma_f32_16x16x32_bf16 a[100:103], a[140:143], v[188:191], a[100:103]
    v_mul_f32 v29, v29, v232
    v_mul_f32 v30, v30, v232
    v_mul_f32 v31, v31, v232
    v_cvt_pk_bf16_f32 v28, v28, v29
    v_cvt_pk_bf16_f32 v29, v30, v31
    v_mfma_f32_16x16x32_bf16 a[104:107], a[144:147], v[184:187], a[104:107]
    ds_write_b64 v242, v[28:29] offset:8928
    ds_read_b128 v[96:99], v243 offset:8704
    v_accvgpr_read_b32 v0, a96
    v_accvgpr_read_b32 v1, a97
    v_accvgpr_read_b32 v2, a98
    v_accvgpr_read_b32 v3, a99
    v_mul_f32 v0, v0, v234
    v_mfma_f32_16x16x32_bf16 a[104:107], a[148:151], v[188:191], a[104:107]
    ds_read_b128 v[100:103], v243 offset:9792
    ds_read_b128 v[104:107], v243 offset:10880
    v_mul_f32 v1, v1, v234
    v_mul_f32 v2, v2, v234
    v_mul_f32 v3, v3, v234
    v_cvt_pk_bf16_f32 v0, v0, v1
    v_cvt_pk_bf16_f32 v1, v2, v3
    v_mfma_f32_16x16x32_bf16 a[108:111], a[152:155], v[184:187], a[108:111]
    ds_read_b128 v[108:111], v243 offset:11968
    ds_write_b64 v242, v[0:1] offset:13056
    v_accvgpr_read_b32 v4, a100
    v_accvgpr_read_b32 v5, a101
    v_accvgpr_read_b32 v6, a102
    v_accvgpr_read_b32 v7, a103
    v_mul_f32 v4, v4, v234
    v_mfma_f32_16x16x32_bf16 a[108:111], a[156:159], v[188:191], a[108:111]
    v_mul_f32 v5, v5, v234
    v_mul_f32 v6, v6, v234
    v_mul_f32 v7, v7, v234
    v_cvt_pk_bf16_f32 v4, v4, v5
    v_cvt_pk_bf16_f32 v5, v6, v7
    v_mfma_f32_16x16x32_bf16 a[112:115], a[160:163], v[184:187], a[112:115]
    ds_write_b64 v242, v[4:5] offset:13088
    s_waitcnt lgkmcnt(2)
    buffer_store_dwordx4 v[96:99], v244, s[20:23], s52 offen offset:0 nt
    v_accvgpr_read_b32 v8, a104
    v_accvgpr_read_b32 v9, a105
    v_accvgpr_read_b32 v10, a106
    v_accvgpr_read_b32 v11, a107
    v_mul_f32 v8, v8, v234
    v_mfma_f32_16x16x32_bf16 a[112:115], a[164:167], v[188:191], a[112:115]
    v_mul_f32 v9, v9, v234
    v_mul_f32 v10, v10, v234
    v_mul_f32 v11, v11, v234
    v_cvt_pk_bf16_f32 v8, v8, v9
    v_cvt_pk_bf16_f32 v9, v10, v11
    v_mfma_f32_16x16x32_bf16 a[116:119], a[168:171], v[184:187], a[116:119]
    ds_write_b64 v242, v[8:9] offset:13120
    v_accvgpr_read_b32 v12, a108
    v_accvgpr_read_b32 v13, a109
    v_accvgpr_read_b32 v14, a110
    v_accvgpr_read_b32 v15, a111
    v_mul_f32 v12, v12, v234
    v_mfma_f32_16x16x32_bf16 a[116:119], a[172:175], v[188:191], a[116:119]
    buffer_store_dwordx4 v[100:103], v244, s[20:23], s52 offen offset:1024 nt
    v_mul_f32 v13, v13, v234
    v_mul_f32 v14, v14, v234
    v_mul_f32 v15, v15, v234
    v_cvt_pk_bf16_f32 v12, v12, v13
    v_cvt_pk_bf16_f32 v13, v14, v15
    v_mfma_f32_16x16x32_bf16 a[120:123], a[176:179], v[184:187], a[120:123]
    ds_write_b64 v242, v[12:13] offset:13152
    v_accvgpr_read_b32 v16, a112
    v_accvgpr_read_b32 v17, a113
    v_accvgpr_read_b32 v18, a114
    v_accvgpr_read_b32 v19, a115
    v_mul_f32 v16, v16, v234
    v_mfma_f32_16x16x32_bf16 a[120:123], a[180:183], v[188:191], a[120:123]
    v_mul_f32 v17, v17, v234
    v_mul_f32 v18, v18, v234
    v_mul_f32 v19, v19, v234
    v_cvt_pk_bf16_f32 v16, v16, v17
    v_cvt_pk_bf16_f32 v17, v18, v19
    v_mfma_f32_16x16x32_bf16 a[124:127], a[184:187], v[184:187], a[124:127]
    ds_write_b64 v242, v[16:17] offset:13184
    buffer_store_dwordx4 v[104:107], v244, s[20:23], s52 offen offset:2048 nt
    v_accvgpr_read_b32 v20, a116
    v_accvgpr_read_b32 v21, a117
    v_accvgpr_read_b32 v22, a118
    v_accvgpr_read_b32 v23, a119
    v_mul_f32 v20, v20, v234
    v_mfma_f32_16x16x32_bf16 a[124:127], a[188:191], v[188:191], a[124:127]
    v_mul_f32 v21, v21, v234
    v_mul_f32 v22, v22, v234
    v_mul_f32 v23, v23, v234
    v_cvt_pk_bf16_f32 v20, v20, v21
    v_cvt_pk_bf16_f32 v21, v22, v23
    ds_write_b64 v242, v[20:21] offset:13216
    v_accvgpr_read_b32 v24, a120
    v_accvgpr_read_b32 v25, a121
    v_accvgpr_read_b32 v26, a122
    v_accvgpr_read_b32 v27, a123
    v_mul_f32 v24, v24, v234
    buffer_store_dwordx4 v[108:111], v244, s[20:23], s52 offen offset:3072 nt
    s_add_u32 s52, s52, 4096
    v_mul_f32 v25, v25, v234
    v_mul_f32 v26, v26, v234
    v_mul_f32 v27, v27, v234
    v_cvt_pk_bf16_f32 v24, v24, v25
    v_cvt_pk_bf16_f32 v25, v26, v27
    ds_write_b64 v242, v[24:25] offset:13248
    v_accvgpr_read_b32 v28, a124
    v_accvgpr_read_b32 v29, a125
    v_accvgpr_read_b32 v30, a126
    v_accvgpr_read_b32 v31, a127
    v_mul_f32 v28, v28, v234
    v_mul_f32 v29, v29, v234
    v_mul_f32 v30, v30, v234
    v_mul_f32 v31, v31, v234
    v_cvt_pk_bf16_f32 v28, v28, v29
    v_cvt_pk_bf16_f32 v29, v30, v31
    ds_write_b64 v242, v[28:29] offset:13280
    ds_read_b128 v[112:115], v243 offset:13056
    ds_read_b128 v[116:119], v243 offset:14144
    ds_read_b128 v[120:123], v243 offset:15232
    ds_read_b128 v[124:127], v243 offset:16320
    s_waitcnt lgkmcnt(3)
    buffer_store_dwordx4 v[112:115], v244, s[20:23], s52 offen offset:0 nt
    s_waitcnt lgkmcnt(2)
    buffer_store_dwordx4 v[116:119], v244, s[20:23], s52 offen offset:1024 nt
    s_waitcnt lgkmcnt(1)
    buffer_store_dwordx4 v[120:123], v244, s[20:23], s52 offen offset:2048 nt
    s_waitcnt lgkmcnt(0)
    buffer_store_dwordx4 v[124:127], v244, s[20:23], s52 offen offset:3072 nt
L_end:
    s_endpgm
L_fb_r2:
    s_mov_b32 s29, 0
    s_branch L_rare0
L_fb_r4:
    s_mov_b32 s29, 1
    s_branch L_rare0
L_fb_ret2:
    s_mov_b32 s29, 2
L_rare0:
    v_max3_f32 v246, v0, v1, 0
    v_max3_f32 v246, v246, v2, v3
    v_max3_f32 v246, v246, v16, v17
    v_max3_f32 v246, v246, v18, v19
    v_max3_f32 v246, v246, v32, v33
    v_max3_f32 v246, v246, v34, v35
    v_max3_f32 v246, v246, v48, v49
    v_max3_f32 v246, v246, v50, v51
    v_mov_b32 v247, v246
    s_nop 1
    v_permlane32_swap_b32 v246, v247
    s_nop 1
    v_max_f32 v246, v246, v247
    v_mov_b32 v247, v246
    s_nop 1
    v_permlane16_swap_b32 v246, v247
    s_nop 1
    v_max_f32 v246, v246, v247
    v_exp_f32 v247, -v246
    v_sub_f32 v0, v0, v246
    v_sub_f32 v1, v1, v246
    v_sub_f32 v2, v2, v246
    v_sub_f32 v3, v3, v246
    v_sub_f32 v16, v16, v246
    v_sub_f32 v17, v17, v246
    v_sub_f32 v18, v18, v246
    v_sub_f32 v19, v19, v246
    v_sub_f32 v32, v32, v246
    v_sub_f32 v33, v33, v246
    v_sub_f32 v34, v34, v246
    v_sub_f32 v35, v35, v246
    v_sub_f32 v48, v48, v246
    v_sub_f32 v49, v49, v246
    v_sub_f32 v50, v50, v246
    v_sub_f32 v51, v51, v246
    v_sub_f32 v64, v64, v246
    v_sub_f32 v65, v65, v246
    v_sub_f32 v66, v66, v246
    v_sub_f32 v67, v67, v246
    v_sub_f32 v80, v80, v246
    v_sub_f32 v81, v81, v246
    v_sub_f32 v82, v82, v246
    v_sub_f32 v83, v83, v246
    v_sub_f32 v96, v96, v246
    v_sub_f32 v97, v97, v246
    v_sub_f32 v98, v98, v246
    v_sub_f32 v99, v99, v246
    v_sub_f32 v112, v112, v246
    v_sub_f32 v113, v113, v246
    v_sub_f32 v114, v114, v246
    v_sub_f32 v115, v115, v246
    v_sub_f32 v192, v192, v246
    v_sub_f32 v193, v193, v246
    v_sub_f32 v194, v194, v246
    v_sub_f32 v195, v195, v246
    v_mul_f32 v208, v248, v247
    v_mov_b32 v209, 0
    v_mov_b32 v210, 0
    v_mov_b32 v211, 0
    v_accvgpr_read_b32 v228, a0
    v_accvgpr_read_b32 v229, a1
    v_accvgpr_read_b32 v230, a2
    v_accvgpr_read_b32 v231, a3
    v_mul_f32 v228, v228, v247
    v_mul_f32 v229, v229, v247
    v_mul_f32 v230, v230, v247
    v_mul_f32 v231, v231, v247
    v_accvgpr_write_b32 a0, v228
    v_accvgpr_write_b32 a1, v229
    v_accvgpr_write_b32 a2, v230
    v_accvgpr_write_b32 a3, v231
    v_accvgpr_read_b32 v228, a4
    v_accvgpr_read_b32 v229, a5
    v_accvgpr_read_b32 v230, a6
    v_accvgpr_read_b32 v231, a7
    v_mul_f32 v228, v228, v247
    v_mul_f32 v229, v229, v247
    v_mul_f32 v230, v230, v247
    v_mul_f32 v231, v231, v247
    v_accvgpr_write_b32 a4, v228
    v_accvgpr_write_b32 a5, v229
    v_accvgpr_write_b32 a6, v230
    v_accvgpr_write_b32 a7, v231
    v_accvgpr_read_b32 v228, a8
    v_accvgpr_read_b32 v229, a9
    v_accvgpr_read_b32 v230, a10
    v_accvgpr_read_b32 v231, a11
    v_mul_f32 v228, v228, v247
    v_mul_f32 v229, v229, v247
    v_mul_f32 v230, v230, v247
    v_mul_f32 v231, v231, v247
    v_accvgpr_write_b32 a8, v228
    v_accvgpr_write_b32 a9, v229
    v_accvgpr_write_b32 a10, v230
    v_accvgpr_write_b32 a11, v231
    v_accvgpr_read_b32 v228, a12
    v_accvgpr_read_b32 v229, a13
    v_accvgpr_read_b32 v230, a14
    v_accvgpr_read_b32 v231, a15
    v_mul_f32 v228, v228, v247
    v_mul_f32 v229, v229, v247
    v_mul_f32 v230, v230, v247
    v_mul_f32 v231, v231, v247
    v_accvgpr_write_b32 a12, v228
    v_accvgpr_write_b32 a13, v229
    v_accvgpr_write_b32 a14, v230
    v_accvgpr_write_b32 a15, v231
    v_accvgpr_read_b32 v228, a16
    v_accvgpr_read_b32 v229, a17
    v_accvgpr_read_b32 v230, a18
    v_accvgpr_read_b32 v231, a19
    v_mul_f32 v228, v228, v247
    v_mul_f32 v229, v229, v247
    v_mul_f32 v230, v230, v247
    v_mul_f32 v231, v231, v247
    v_accvgpr_write_b32 a16, v228
    v_accvgpr_write_b32 a17, v229
    v_accvgpr_write_b32 a18, v230
    v_accvgpr_write_b32 a19, v231
    v_accvgpr_read_b32 v228, a20
    v_accvgpr_read_b32 v229, a21
    v_accvgpr_read_b32 v230, a22
    v_accvgpr_read_b32 v231, a23
    v_mul_f32 v228, v228, v247
    v_mul_f32 v229, v229, v247
    v_mul_f32 v230, v230, v247
    v_mul_f32 v231, v231, v247
    v_accvgpr_write_b32 a20, v228
    v_accvgpr_write_b32 a21, v229
    v_accvgpr_write_b32 a22, v230
    v_accvgpr_write_b32 a23, v231
    v_accvgpr_read_b32 v228, a24
    v_accvgpr_read_b32 v229, a25
    v_accvgpr_read_b32 v230, a26
    v_accvgpr_read_b32 v231, a27
    v_mul_f32 v228, v228, v247
    v_mul_f32 v229, v229, v247
    v_mul_f32 v230, v230, v247
    v_mul_f32 v231, v231, v247
    v_accvgpr_write_b32 a24, v228
    v_accvgpr_write_b32 a25, v229
    v_accvgpr_write_b32 a26, v230
    v_accvgpr_write_b32 a27, v231
    v_accvgpr_read_b32 v228, a28
    v_accvgpr_read_b32 v229, a29
    v_accvgpr_read_b32 v230, a30
    v_accvgpr_read_b32 v231, a31
    v_mul_f32 v228, v228, v247
    v_mul_f32 v229, v229, v247
    v_mul_f32 v230, v230, v247
    v_mul_f32 v231, v231, v247
    v_accvgpr_write_b32 a28, v228
    v_accvgpr_write_b32 a29, v229
    v_accvgpr_write_b32 a30, v230
    v_accvgpr_write_b32 a31, v231
    v_max3_f32 v246, v4, v5, 0
    v_max3_f32 v246, v246, v6, v7
    v_max3_f32 v246, v246, v20, v21
    v_max3_f32 v246, v246, v22, v23
    v_max3_f32 v246, v246, v36, v37
    v_max3_f32 v246, v246, v38, v39
    v_max3_f32 v246, v246, v52, v53
    v_max3_f32 v246, v246, v54, v55
    v_mov_b32 v247, v246
    s_nop 1
    v_permlane32_swap_b32 v246, v247
    s_nop 1
    v_max_f32 v246, v246, v247
    v_mov_b32 v247, v246
    s_nop 1
    v_permlane16_swap_b32 v246, v247
    s_nop 1
    v_max_f32 v246, v246, v247
    v_exp_f32 v247, -v246
    v_sub_f32 v4, v4, v246
    v_sub_f32 v5, v5, v246
    v_sub_f32 v6, v6, v246
    v_sub_f32 v7, v7, v246
    v_sub_f32 v20, v20, v246
    v_sub_f32 v21, v21, v246
    v_sub_f32 v22, v22, v246
    v_sub_f32 v23, v23, v246
    v_sub_f32 v36, v36, v246
    v_sub_f32 v37, v37, v246
    v_sub_f32 v38, v38, v246
    v_sub_f32 v39, v39, v246
    v_sub_f32 v52, v52, v246
    v_sub_f32 v53, v53, v246
    v_sub_f32 v54, v54, v246
    v_sub_f32 v55, v55, v246
    v_sub_f32 v68, v68, v246
    v_sub_f32 v69, v69, v246
    v_sub_f32 v70, v70, v246
    v_sub_f32 v71, v71, v246
    v_sub_f32 v84, v84, v246
    v_sub_f32 v85, v85, v246
    v_sub_f32 v86, v86, v246
    v_sub_f32 v87, v87, v246
    v_sub_f32 v100, v100, v246
    v_sub_f32 v101, v101, v246
    v_sub_f32 v102, v102, v246
    v_sub_f32 v103, v103, v246
    v_sub_f32 v116, v116, v246
    v_sub_f32 v117, v117, v246
    v_sub_f32 v118, v118, v246
    v_sub_f32 v119, v119, v246
    v_sub_f32 v196, v196, v246
    v_sub_f32 v197, v197, v246
    v_sub_f32 v198, v198, v246
    v_sub_f32 v199, v199, v246
    v_mul_f32 v212, v249, v247
    v_mov_b32 v213, 0
    v_mov_b32 v214, 0
    v_mov_b32 v215, 0
    v_accvgpr_read_b32 v228, a32
    v_accvgpr_read_b32 v229, a33
    v_accvgpr_read_b32 v230, a34
    v_accvgpr_read_b32 v231, a35
    v_mul_f32 v228, v228, v247
    v_mul_f32 v229, v229, v247
    v_mul_f32 v230, v230, v247
    v_mul_f32 v231, v231, v247
    v_accvgpr_write_b32 a32, v228
    v_accvgpr_write_b32 a33, v229
    v_accvgpr_write_b32 a34, v230
    v_accvgpr_write_b32 a35, v231
    v_accvgpr_read_b32 v228, a36
    v_accvgpr_read_b32 v229, a37
    v_accvgpr_read_b32 v230, a38
    v_accvgpr_read_b32 v231, a39
    v_mul_f32 v228, v228, v247
    v_mul_f32 v229, v229, v247
    v_mul_f32 v230, v230, v247
    v_mul_f32 v231, v231, v247
    v_accvgpr_write_b32 a36, v228
    v_accvgpr_write_b32 a37, v229
    v_accvgpr_write_b32 a38, v230
    v_accvgpr_write_b32 a39, v231
    v_accvgpr_read_b32 v228, a40
    v_accvgpr_read_b32 v229, a41
    v_accvgpr_read_b32 v230, a42
    v_accvgpr_read_b32 v231, a43
    v_mul_f32 v228, v228, v247
    v_mul_f32 v229, v229, v247
    v_mul_f32 v230, v230, v247
    v_mul_f32 v231, v231, v247
    v_accvgpr_write_b32 a40, v228
    v_accvgpr_write_b32 a41, v229
    v_accvgpr_write_b32 a42, v230
    v_accvgpr_write_b32 a43, v231
    v_accvgpr_read_b32 v228, a44
    v_accvgpr_read_b32 v229, a45
    v_accvgpr_read_b32 v230, a46
    v_accvgpr_read_b32 v231, a47
    v_mul_f32 v228, v228, v247
    v_mul_f32 v229, v229, v247
    v_mul_f32 v230, v230, v247
    v_mul_f32 v231, v231, v247
    v_accvgpr_write_b32 a44, v228
    v_accvgpr_write_b32 a45, v229
    v_accvgpr_write_b32 a46, v230
    v_accvgpr_write_b32 a47, v231
    v_accvgpr_read_b32 v228, a48
    v_accvgpr_read_b32 v229, a49
    v_accvgpr_read_b32 v230, a50
    v_accvgpr_read_b32 v231, a51
    v_mul_f32 v228, v228, v247
    v_mul_f32 v229, v229, v247
    v_mul_f32 v230, v230, v247
    v_mul_f32 v231, v231, v247
    v_accvgpr_write_b32 a48, v228
    v_accvgpr_write_b32 a49, v229
    v_accvgpr_write_b32 a50, v230
    v_accvgpr_write_b32 a51, v231
    v_accvgpr_read_b32 v228, a52
    v_accvgpr_read_b32 v229, a53
    v_accvgpr_read_b32 v230, a54
    v_accvgpr_read_b32 v231, a55
    v_mul_f32 v228, v228, v247
    v_mul_f32 v229, v229, v247
    v_mul_f32 v230, v230, v247
    v_mul_f32 v231, v231, v247
    v_accvgpr_write_b32 a52, v228
    v_accvgpr_write_b32 a53, v229
    v_accvgpr_write_b32 a54, v230
    v_accvgpr_write_b32 a55, v231
    v_accvgpr_read_b32 v228, a56
    v_accvgpr_read_b32 v229, a57
    v_accvgpr_read_b32 v230, a58
    v_accvgpr_read_b32 v231, a59
    v_mul_f32 v228, v228, v247
    v_mul_f32 v229, v229, v247
    v_mul_f32 v230, v230, v247
    v_mul_f32 v231, v231, v247
    v_accvgpr_write_b32 a56, v228
    v_accvgpr_write_b32 a57, v229
    v_accvgpr_write_b32 a58, v230
    v_accvgpr_write_b32 a59, v231
    v_accvgpr_read_b32 v228, a60
    v_accvgpr_read_b32 v229, a61
    v_accvgpr_read_b32 v230, a62
    v_accvgpr_read_b32 v231, a63
    v_mul_f32 v228, v228, v247
    v_mul_f32 v229, v229, v247
    v_mul_f32 v230, v230, v247
    v_mul_f32 v231, v231, v247
    v_accvgpr_write_b32 a60, v228
    v_accvgpr_write_b32 a61, v229
    v_accvgpr_write_b32 a62, v230
    v_accvgpr_write_b32 a63, v231
    v_max3_f32 v246, v8, v9, 0
    v_max3_f32 v246, v246, v10, v11
    v_max3_f32 v246, v246, v24, v25
    v_max3_f32 v246, v246, v26, v27
    v_max3_f32 v246, v246, v40, v41
    v_max3_f32 v246, v246, v42, v43
    v_max3_f32 v246, v246, v56, v57
    v_max3_f32 v246, v246, v58, v59
    v_mov_b32 v247, v246
    s_nop 1
    v_permlane32_swap_b32 v246, v247
    s_nop 1
    v_max_f32 v246, v246, v247
    v_mov_b32 v247, v246
    s_nop 1
    v_permlane16_swap_b32 v246, v247
    s_nop 1
    v_max_f32 v246, v246, v247
    v_exp_f32 v247, -v246
    v_sub_f32 v8, v8, v246
    v_sub_f32 v9, v9, v246
    v_sub_f32 v10, v10, v246
    v_sub_f32 v11, v11, v246
    v_sub_f32 v24, v24, v246
    v_sub_f32 v25, v25, v246
    v_sub_f32 v26, v26, v246
    v_sub_f32 v27, v27, v246
    v_sub_f32 v40, v40, v246
    v_sub_f32 v41, v41, v246
    v_sub_f32 v42, v42, v246
    v_sub_f32 v43, v43, v246
    v_sub_f32 v56, v56, v246
    v_sub_f32 v57, v57, v246
    v_sub_f32 v58, v58, v246
    v_sub_f32 v59, v59, v246
    v_sub_f32 v72, v72, v246
    v_sub_f32 v73, v73, v246
    v_sub_f32 v74, v74, v246
    v_sub_f32 v75, v75, v246
    v_sub_f32 v88, v88, v246
    v_sub_f32 v89, v89, v246
    v_sub_f32 v90, v90, v246
    v_sub_f32 v91, v91, v246
    v_sub_f32 v104, v104, v246
    v_sub_f32 v105, v105, v246
    v_sub_f32 v106, v106, v246
    v_sub_f32 v107, v107, v246
    v_sub_f32 v120, v120, v246
    v_sub_f32 v121, v121, v246
    v_sub_f32 v122, v122, v246
    v_sub_f32 v123, v123, v246
    v_sub_f32 v200, v200, v246
    v_sub_f32 v201, v201, v246
    v_sub_f32 v202, v202, v246
    v_sub_f32 v203, v203, v246
    v_mul_f32 v216, v250, v247
    v_mov_b32 v217, 0
    v_mov_b32 v218, 0
    v_mov_b32 v219, 0
    v_accvgpr_read_b32 v228, a64
    v_accvgpr_read_b32 v229, a65
    v_accvgpr_read_b32 v230, a66
    v_accvgpr_read_b32 v231, a67
    v_mul_f32 v228, v228, v247
    v_mul_f32 v229, v229, v247
    v_mul_f32 v230, v230, v247
    v_mul_f32 v231, v231, v247
    v_accvgpr_write_b32 a64, v228
    v_accvgpr_write_b32 a65, v229
    v_accvgpr_write_b32 a66, v230
    v_accvgpr_write_b32 a67, v231
    v_accvgpr_read_b32 v228, a68
    v_accvgpr_read_b32 v229, a69
    v_accvgpr_read_b32 v230, a70
    v_accvgpr_read_b32 v231, a71
    v_mul_f32 v228, v228, v247
    v_mul_f32 v229, v229, v247
    v_mul_f32 v230, v230, v247
    v_mul_f32 v231, v231, v247
    v_accvgpr_write_b32 a68, v228
    v_accvgpr_write_b32 a69, v229
    v_accvgpr_write_b32 a70, v230
    v_accvgpr_write_b32 a71, v231
    v_accvgpr_read_b32 v228, a72
    v_accvgpr_read_b32 v229, a73
    v_accvgpr_read_b32 v230, a74
    v_accvgpr_read_b32 v231, a75
    v_mul_f32 v228, v228, v247
    v_mul_f32 v229, v229, v247
    v_mul_f32 v230, v230, v247
    v_mul_f32 v231, v231, v247
    v_accvgpr_write_b32 a72, v228
    v_accvgpr_write_b32 a73, v229
    v_accvgpr_write_b32 a74, v230
    v_accvgpr_write_b32 a75, v231
    v_accvgpr_read_b32 v228, a76
    v_accvgpr_read_b32 v229, a77
    v_accvgpr_read_b32 v230, a78
    v_accvgpr_read_b32 v231, a79
    v_mul_f32 v228, v228, v247
    v_mul_f32 v229, v229, v247
    v_mul_f32 v230, v230, v247
    v_mul_f32 v231, v231, v247
    v_accvgpr_write_b32 a76, v228
    v_accvgpr_write_b32 a77, v229
    v_accvgpr_write_b32 a78, v230
    v_accvgpr_write_b32 a79, v231
    v_accvgpr_read_b32 v228, a80
    v_accvgpr_read_b32 v229, a81
    v_accvgpr_read_b32 v230, a82
    v_accvgpr_read_b32 v231, a83
    v_mul_f32 v228, v228, v247
    v_mul_f32 v229, v229, v247
    v_mul_f32 v230, v230, v247
    v_mul_f32 v231, v231, v247
    v_accvgpr_write_b32 a80, v228
    v_accvgpr_write_b32 a81, v229
    v_accvgpr_write_b32 a82, v230
    v_accvgpr_write_b32 a83, v231
    v_accvgpr_read_b32 v228, a84
    v_accvgpr_read_b32 v229, a85
    v_accvgpr_read_b32 v230, a86
    v_accvgpr_read_b32 v231, a87
    v_mul_f32 v228, v228, v247
    v_mul_f32 v229, v229, v247
    v_mul_f32 v230, v230, v247
    v_mul_f32 v231, v231, v247
    v_accvgpr_write_b32 a84, v228
    v_accvgpr_write_b32 a85, v229
    v_accvgpr_write_b32 a86, v230
    v_accvgpr_write_b32 a87, v231
    v_accvgpr_read_b32 v228, a88
    v_accvgpr_read_b32 v229, a89
    v_accvgpr_read_b32 v230, a90
    v_accvgpr_read_b32 v231, a91
    v_mul_f32 v228, v228, v247
    v_mul_f32 v229, v229, v247
    v_mul_f32 v230, v230, v247
    v_mul_f32 v231, v231, v247
    v_accvgpr_write_b32 a88, v228
    v_accvgpr_write_b32 a89, v229
    v_accvgpr_write_b32 a90, v230
    v_accvgpr_write_b32 a91, v231
    v_accvgpr_read_b32 v228, a92
    v_accvgpr_read_b32 v229, a93
    v_accvgpr_read_b32 v230, a94
    v_accvgpr_read_b32 v231, a95
    v_mul_f32 v228, v228, v247
    v_mul_f32 v229, v229, v247
    v_mul_f32 v230, v230, v247
    v_mul_f32 v231, v231, v247
    v_accvgpr_write_b32 a92, v228
    v_accvgpr_write_b32 a93, v229
    v_accvgpr_write_b32 a94, v230
    v_accvgpr_write_b32 a95, v231
    v_max3_f32 v246, v12, v13, 0
    v_max3_f32 v246, v246, v14, v15
    v_max3_f32 v246, v246, v28, v29
    v_max3_f32 v246, v246, v30, v31
    v_max3_f32 v246, v246, v44, v45
    v_max3_f32 v246, v246, v46, v47
    v_max3_f32 v246, v246, v60, v61
    v_max3_f32 v246, v246, v62, v63
    v_mov_b32 v247, v246
    s_nop 1
    v_permlane32_swap_b32 v246, v247
    s_nop 1
    v_max_f32 v246, v246, v247
    v_mov_b32 v247, v246
    s_nop 1
    v_permlane16_swap_b32 v246, v247
    s_nop 1
    v_max_f32 v246, v246, v247
    v_exp_f32 v247, -v246
    v_sub_f32 v12, v12, v246
    v_sub_f32 v13, v13, v246
    v_sub_f32 v14, v14, v246
    v_sub_f32 v15, v15, v246
    v_sub_f32 v28, v28, v246
    v_sub_f32 v29, v29, v246
    v_sub_f32 v30, v30, v246
    v_sub_f32 v31, v31, v246
    v_sub_f32 v44, v44, v246
    v_sub_f32 v45, v45, v246
    v_sub_f32 v46, v46, v246
    v_sub_f32 v47, v47, v246
    v_sub_f32 v60, v60, v246
    v_sub_f32 v61, v61, v246
    v_sub_f32 v62, v62, v246
    v_sub_f32 v63, v63, v246
    v_sub_f32 v76, v76, v246
    v_sub_f32 v77, v77, v246
    v_sub_f32 v78, v78, v246
    v_sub_f32 v79, v79, v246
    v_sub_f32 v92, v92, v246
    v_sub_f32 v93, v93, v246
    v_sub_f32 v94, v94, v246
    v_sub_f32 v95, v95, v246
    v_sub_f32 v108, v108, v246
    v_sub_f32 v109, v109, v246
    v_sub_f32 v110, v110, v246
    v_sub_f32 v111, v111, v246
    v_sub_f32 v124, v124, v246
    v_sub_f32 v125, v125, v246
    v_sub_f32 v126, v126, v246
    v_sub_f32 v127, v127, v246
    v_sub_f32 v204, v204, v246
    v_sub_f32 v205, v205, v246
    v_sub_f32 v206, v206, v246
    v_sub_f32 v207, v207, v246
    v_mul_f32 v220, v251, v247
    v_mov_b32 v221, 0
    v_mov_b32 v222, 0
    v_mov_b32 v223, 0
    v_accvgpr_read_b32 v228, a96
    v_accvgpr_read_b32 v229, a97
    v_accvgpr_read_b32 v230, a98
    v_accvgpr_read_b32 v231, a99
    v_mul_f32 v228, v228, v247
    v_mul_f32 v229, v229, v247
    v_mul_f32 v230, v230, v247
    v_mul_f32 v231, v231, v247
    v_accvgpr_write_b32 a96, v228
    v_accvgpr_write_b32 a97, v229
    v_accvgpr_write_b32 a98, v230
    v_accvgpr_write_b32 a99, v231
    v_accvgpr_read_b32 v228, a100
    v_accvgpr_read_b32 v229, a101
    v_accvgpr_read_b32 v230, a102
    v_accvgpr_read_b32 v231, a103
    v_mul_f32 v228, v228, v247
    v_mul_f32 v229, v229, v247
    v_mul_f32 v230, v230, v247
    v_mul_f32 v231, v231, v247
    v_accvgpr_write_b32 a100, v228
    v_accvgpr_write_b32 a101, v229
    v_accvgpr_write_b32 a102, v230
    v_accvgpr_write_b32 a103, v231
    v_accvgpr_read_b32 v228, a104
    v_accvgpr_read_b32 v229, a105
    v_accvgpr_read_b32 v230, a106
    v_accvgpr_read_b32 v231, a107
    v_mul_f32 v228, v228, v247
    v_mul_f32 v229, v229, v247
    v_mul_f32 v230, v230, v247
    v_mul_f32 v231, v231, v247
    v_accvgpr_write_b32 a104, v228
    v_accvgpr_write_b32 a105, v229
    v_accvgpr_write_b32 a106, v230
    v_accvgpr_write_b32 a107, v231
    v_accvgpr_read_b32 v228, a108
    v_accvgpr_read_b32 v229, a109
    v_accvgpr_read_b32 v230, a110
    v_accvgpr_read_b32 v231, a111
    v_mul_f32 v228, v228, v247
    v_mul_f32 v229, v229, v247
    v_mul_f32 v230, v230, v247
    v_mul_f32 v231, v231, v247
    v_accvgpr_write_b32 a108, v228
    v_accvgpr_write_b32 a109, v229
    v_accvgpr_write_b32 a110, v230
    v_accvgpr_write_b32 a111, v231
    v_accvgpr_read_b32 v228, a112
    v_accvgpr_read_b32 v229, a113
    v_accvgpr_read_b32 v230, a114
    v_accvgpr_read_b32 v231, a115
    v_mul_f32 v228, v228, v247
    v_mul_f32 v229, v229, v247
    v_mul_f32 v230, v230, v247
    v_mul_f32 v231, v231, v247
    v_accvgpr_write_b32 a112, v228
    v_accvgpr_write_b32 a113, v229
    v_accvgpr_write_b32 a114, v230
    v_accvgpr_write_b32 a115, v231
    v_accvgpr_read_b32 v228, a116
    v_accvgpr_read_b32 v229, a117
    v_accvgpr_read_b32 v230, a118
    v_accvgpr_read_b32 v231, a119
    v_mul_f32 v228, v228, v247
    v_mul_f32 v229, v229, v247
    v_mul_f32 v230, v230, v247
    v_mul_f32 v231, v231, v247
    v_accvgpr_write_b32 a116, v228
    v_accvgpr_write_b32 a117, v229
    v_accvgpr_write_b32 a118, v230
    v_accvgpr_write_b32 a119, v231
    v_accvgpr_read_b32 v228, a120
    v_accvgpr_read_b32 v229, a121
    v_accvgpr_read_b32 v230, a122
    v_accvgpr_read_b32 v231, a123
    v_mul_f32 v228, v228, v247
    v_mul_f32 v229, v229, v247
    v_mul_f32 v230, v230, v247
    v_mul_f32 v231, v231, v247
    v_accvgpr_write_b32 a120, v228
    v_accvgpr_write_b32 a121, v229
    v_accvgpr_write_b32 a122, v230
    v_accvgpr_write_b32 a123, v231
    v_accvgpr_read_b32 v228, a124
    v_accvgpr_read_b32 v229, a125
    v_accvgpr_read_b32 v230, a126
    v_accvgpr_read_b32 v231, a127
    v_mul_f32 v228, v228, v247
    v_mul_f32 v229, v229, v247
    v_mul_f32 v230, v230, v247
    v_mul_f32 v231, v231, v247
    v_accvgpr_write_b32 a124, v228
    v_accvgpr_write_b32 a125, v229
    v_accvgpr_write_b32 a126, v230
    v_accvgpr_write_b32 a127, v231
    v_exp_f32 v228, v0
    v_exp_f32 v229, v1
    v_exp_f32 v230, v2
    v_exp_f32 v231, v3
    v_exp_f32 v232, v16
    v_exp_f32 v233, v17
    v_exp_f32 v234, v18
    v_exp_f32 v235, v19
    s_nop 0
    v_cvt_pk_bf16_f32 v128, v228, v229
    v_cvt_pk_bf16_f32 v129, v230, v231
    v_cvt_pk_bf16_f32 v130, v232, v233
    v_cvt_pk_bf16_f32 v131, v234, v235
    v_exp_f32 v228, v32
    v_exp_f32 v229, v33
    v_exp_f32 v230, v34
    v_exp_f32 v231, v35
    v_exp_f32 v232, v48
    v_exp_f32 v233, v49
    v_exp_f32 v234, v50
    v_exp_f32 v235, v51
    s_nop 0
    v_cvt_pk_bf16_f32 v132, v228, v229
    v_cvt_pk_bf16_f32 v133, v230, v231
    v_cvt_pk_bf16_f32 v134, v232, v233
    v_cvt_pk_bf16_f32 v135, v234, v235
    s_nop 1
    v_smfmac_f32_16x16x64_bf16 v[208:211], v[236:239], v[128:135], v245
    v_exp_f32 v228, v4
    v_exp_f32 v229, v5
    v_exp_f32 v230, v6
    v_exp_f32 v231, v7
    v_exp_f32 v232, v20
    v_exp_f32 v233, v21
    v_exp_f32 v234, v22
    v_exp_f32 v235, v23
    s_nop 0
    v_cvt_pk_bf16_f32 v136, v228, v229
    v_cvt_pk_bf16_f32 v137, v230, v231
    v_cvt_pk_bf16_f32 v138, v232, v233
    v_cvt_pk_bf16_f32 v139, v234, v235
    v_exp_f32 v228, v36
    v_exp_f32 v229, v37
    v_exp_f32 v230, v38
    v_exp_f32 v231, v39
    v_exp_f32 v232, v52
    v_exp_f32 v233, v53
    v_exp_f32 v234, v54
    v_exp_f32 v235, v55
    s_nop 0
    v_cvt_pk_bf16_f32 v140, v228, v229
    v_cvt_pk_bf16_f32 v141, v230, v231
    v_cvt_pk_bf16_f32 v142, v232, v233
    v_cvt_pk_bf16_f32 v143, v234, v235
    s_nop 1
    v_smfmac_f32_16x16x64_bf16 v[212:215], v[236:239], v[136:143], v245
    v_exp_f32 v228, v8
    v_exp_f32 v229, v9
    v_exp_f32 v230, v10
    v_exp_f32 v231, v11
    v_exp_f32 v232, v24
    v_exp_f32 v233, v25
    v_exp_f32 v234, v26
    v_exp_f32 v235, v27
    s_nop 0
    v_cvt_pk_bf16_f32 v144, v228, v229
    v_cvt_pk_bf16_f32 v145, v230, v231
    v_cvt_pk_bf16_f32 v146, v232, v233
    v_cvt_pk_bf16_f32 v147, v234, v235
    v_exp_f32 v228, v40
    v_exp_f32 v229, v41
    v_exp_f32 v230, v42
    v_exp_f32 v231, v43
    v_exp_f32 v232, v56
    v_exp_f32 v233, v57
    v_exp_f32 v234, v58
    v_exp_f32 v235, v59
    s_nop 0
    v_cvt_pk_bf16_f32 v148, v228, v229
    v_cvt_pk_bf16_f32 v149, v230, v231
    v_cvt_pk_bf16_f32 v150, v232, v233
    v_cvt_pk_bf16_f32 v151, v234, v235
    s_nop 1
    v_smfmac_f32_16x16x64_bf16 v[216:219], v[236:239], v[144:151], v245
    v_exp_f32 v228, v12
    v_exp_f32 v229, v13
    v_exp_f32 v230, v14
    v_exp_f32 v231, v15
    v_exp_f32 v232, v28
    v_exp_f32 v233, v29
    v_exp_f32 v234, v30
    v_exp_f32 v235, v31
    s_nop 0
    v_cvt_pk_bf16_f32 v152, v228, v229
    v_cvt_pk_bf16_f32 v153, v230, v231
    v_cvt_pk_bf16_f32 v154, v232, v233
    v_cvt_pk_bf16_f32 v155, v234, v235
    v_exp_f32 v228, v44
    v_exp_f32 v229, v45
    v_exp_f32 v230, v46
    v_exp_f32 v231, v47
    v_exp_f32 v232, v60
    v_exp_f32 v233, v61
    v_exp_f32 v234, v62
    v_exp_f32 v235, v63
    s_nop 0
    v_cvt_pk_bf16_f32 v156, v228, v229
    v_cvt_pk_bf16_f32 v157, v230, v231
    v_cvt_pk_bf16_f32 v158, v232, v233
    v_cvt_pk_bf16_f32 v159, v234, v235
    s_nop 1
    v_smfmac_f32_16x16x64_bf16 v[220:223], v[236:239], v[152:159], v245
    s_nop 7
    s_nop 7
    v_add_f32 v224, v208, v209
    v_add_f32 v225, v212, v213
    v_add_f32 v226, v216, v217
    v_add_f32 v227, v220, v221
    s_cmp_eq_u32 s29, 0
    s_cbranch_scc1 L_r2
    s_cmp_eq_u32 s29, 1
    s_cbranch_scc1 L_r4
    s_branch L_ret2
L_fb_r1:
    s_mov_b32 s29, 0
    s_branch L_rare1
L_fb_r3:
    s_mov_b32 s29, 1
    s_branch L_rare1
L_fb_ret1:
    s_mov_b32 s29, 2
    s_branch L_rare1
L_fb_ret3:
    s_mov_b32 s29, 3
L_rare1:
    v_max3_f32 v246, v64, v65, 0
    v_max3_f32 v246, v246, v66, v67
    v_max3_f32 v246, v246, v80, v81
    v_max3_f32 v246, v246, v82, v83
    v_max3_f32 v246, v246, v96, v97
    v_max3_f32 v246, v246, v98, v99
    v_max3_f32 v246, v246, v112, v113
    v_max3_f32 v246, v246, v114, v115
    v_mov_b32 v247, v246
    s_nop 1
    v_permlane32_swap_b32 v246, v247
    s_nop 1
    v_max_f32 v246, v246, v247
    v_mov_b32 v247, v246
    s_nop 1
    v_permlane16_swap_b32 v246, v247
    s_nop 1
    v_max_f32 v246, v246, v247
    v_exp_f32 v247, -v246
    v_sub_f32 v64, v64, v246
    v_sub_f32 v65, v65, v246
    v_sub_f32 v66, v66, v246
    v_sub_f32 v67, v67, v246
    v_sub_f32 v80, v80, v246
    v_sub_f32 v81, v81, v246
    v_sub_f32 v82, v82, v246
    v_sub_f32 v83, v83, v246
    v_sub_f32 v96, v96, v246
    v_sub_f32 v97, v97, v246
    v_sub_f32 v98, v98, v246
    v_sub_f32 v99, v99, v246
    v_sub_f32 v112, v112, v246
    v_sub_f32 v113, v113, v246
    v_sub_f32 v114, v114, v246
    v_sub_f32 v115, v115, v246
    v_sub_f32 v0, v0, v246
    v_sub_f32 v1, v1, v246
    v_sub_f32 v2, v2, v246
    v_sub_f32 v3, v3, v246
    v_sub_f32 v16, v16, v246
    v_sub_f32 v17, v17, v246
    v_sub_f32 v18, v18, v246
    v_sub_f32 v19, v19, v246
    v_sub_f32 v32, v32, v246
    v_sub_f32 v33, v33, v246
    v_sub_f32 v34, v34, v246
    v_sub_f32 v35, v35, v246
    v_sub_f32 v48, v48, v246
    v_sub_f32 v49, v49, v246
    v_sub_f32 v50, v50, v246
    v_sub_f32 v51, v51, v246
    v_sub_f32 v192, v192, v246
    v_sub_f32 v193, v193, v246
    v_sub_f32 v194, v194, v246
    v_sub_f32 v195, v195, v246
    v_mul_f32 v208, v224, v247
    v_mov_b32 v209, 0
    v_mov_b32 v210, 0
    v_mov_b32 v211, 0
    v_accvgpr_read_b32 v228, a0
    v_accvgpr_read_b32 v229, a1
    v_accvgpr_read_b32 v230, a2
    v_accvgpr_read_b32 v231, a3
    v_mul_f32 v228, v228, v247
    v_mul_f32 v229, v229, v247
    v_mul_f32 v230, v230, v247
    v_mul_f32 v231, v231, v247
    v_accvgpr_write_b32 a0, v228
    v_accvgpr_write_b32 a1, v229
    v_accvgpr_write_b32 a2, v230
    v_accvgpr_write_b32 a3, v231
    v_accvgpr_read_b32 v228, a4
    v_accvgpr_read_b32 v229, a5
    v_accvgpr_read_b32 v230, a6
    v_accvgpr_read_b32 v231, a7
    v_mul_f32 v228, v228, v247
    v_mul_f32 v229, v229, v247
    v_mul_f32 v230, v230, v247
    v_mul_f32 v231, v231, v247
    v_accvgpr_write_b32 a4, v228
    v_accvgpr_write_b32 a5, v229
    v_accvgpr_write_b32 a6, v230
    v_accvgpr_write_b32 a7, v231
    v_accvgpr_read_b32 v228, a8
    v_accvgpr_read_b32 v229, a9
    v_accvgpr_read_b32 v230, a10
    v_accvgpr_read_b32 v231, a11
    v_mul_f32 v228, v228, v247
    v_mul_f32 v229, v229, v247
    v_mul_f32 v230, v230, v247
    v_mul_f32 v231, v231, v247
    v_accvgpr_write_b32 a8, v228
    v_accvgpr_write_b32 a9, v229
    v_accvgpr_write_b32 a10, v230
    v_accvgpr_write_b32 a11, v231
    v_accvgpr_read_b32 v228, a12
    v_accvgpr_read_b32 v229, a13
    v_accvgpr_read_b32 v230, a14
    v_accvgpr_read_b32 v231, a15
    v_mul_f32 v228, v228, v247
    v_mul_f32 v229, v229, v247
    v_mul_f32 v230, v230, v247
    v_mul_f32 v231, v231, v247
    v_accvgpr_write_b32 a12, v228
    v_accvgpr_write_b32 a13, v229
    v_accvgpr_write_b32 a14, v230
    v_accvgpr_write_b32 a15, v231
    v_accvgpr_read_b32 v228, a16
    v_accvgpr_read_b32 v229, a17
    v_accvgpr_read_b32 v230, a18
    v_accvgpr_read_b32 v231, a19
    v_mul_f32 v228, v228, v247
    v_mul_f32 v229, v229, v247
    v_mul_f32 v230, v230, v247
    v_mul_f32 v231, v231, v247
    v_accvgpr_write_b32 a16, v228
    v_accvgpr_write_b32 a17, v229
    v_accvgpr_write_b32 a18, v230
    v_accvgpr_write_b32 a19, v231
    v_accvgpr_read_b32 v228, a20
    v_accvgpr_read_b32 v229, a21
    v_accvgpr_read_b32 v230, a22
    v_accvgpr_read_b32 v231, a23
    v_mul_f32 v228, v228, v247
    v_mul_f32 v229, v229, v247
    v_mul_f32 v230, v230, v247
    v_mul_f32 v231, v231, v247
    v_accvgpr_write_b32 a20, v228
    v_accvgpr_write_b32 a21, v229
    v_accvgpr_write_b32 a22, v230
    v_accvgpr_write_b32 a23, v231
    v_accvgpr_read_b32 v228, a24
    v_accvgpr_read_b32 v229, a25
    v_accvgpr_read_b32 v230, a26
    v_accvgpr_read_b32 v231, a27
    v_mul_f32 v228, v228, v247
    v_mul_f32 v229, v229, v247
    v_mul_f32 v230, v230, v247
    v_mul_f32 v231, v231, v247
    v_accvgpr_write_b32 a24, v228
    v_accvgpr_write_b32 a25, v229
    v_accvgpr_write_b32 a26, v230
    v_accvgpr_write_b32 a27, v231
    v_accvgpr_read_b32 v228, a28
    v_accvgpr_read_b32 v229, a29
    v_accvgpr_read_b32 v230, a30
    v_accvgpr_read_b32 v231, a31
    v_mul_f32 v228, v228, v247
    v_mul_f32 v229, v229, v247
    v_mul_f32 v230, v230, v247
    v_mul_f32 v231, v231, v247
    v_accvgpr_write_b32 a28, v228
    v_accvgpr_write_b32 a29, v229
    v_accvgpr_write_b32 a30, v230
    v_accvgpr_write_b32 a31, v231
    v_max3_f32 v246, v68, v69, 0
    v_max3_f32 v246, v246, v70, v71
    v_max3_f32 v246, v246, v84, v85
    v_max3_f32 v246, v246, v86, v87
    v_max3_f32 v246, v246, v100, v101
    v_max3_f32 v246, v246, v102, v103
    v_max3_f32 v246, v246, v116, v117
    v_max3_f32 v246, v246, v118, v119
    v_mov_b32 v247, v246
    s_nop 1
    v_permlane32_swap_b32 v246, v247
    s_nop 1
    v_max_f32 v246, v246, v247
    v_mov_b32 v247, v246
    s_nop 1
    v_permlane16_swap_b32 v246, v247
    s_nop 1
    v_max_f32 v246, v246, v247
    v_exp_f32 v247, -v246
    v_sub_f32 v68, v68, v246
    v_sub_f32 v69, v69, v246
    v_sub_f32 v70, v70, v246
    v_sub_f32 v71, v71, v246
    v_sub_f32 v84, v84, v246
    v_sub_f32 v85, v85, v246
    v_sub_f32 v86, v86, v246
    v_sub_f32 v87, v87, v246
    v_sub_f32 v100, v100, v246
    v_sub_f32 v101, v101, v246
    v_sub_f32 v102, v102, v246
    v_sub_f32 v103, v103, v246
    v_sub_f32 v116, v116, v246
    v_sub_f32 v117, v117, v246
    v_sub_f32 v118, v118, v246
    v_sub_f32 v119, v119, v246
    v_sub_f32 v4, v4, v246
    v_sub_f32 v5, v5, v246
    v_sub_f32 v6, v6, v246
    v_sub_f32 v7, v7, v246
    v_sub_f32 v20, v20, v246
    v_sub_f32 v21, v21, v246
    v_sub_f32 v22, v22, v246
    v_sub_f32 v23, v23, v246
    v_sub_f32 v36, v36, v246
    v_sub_f32 v37, v37, v246
    v_sub_f32 v38, v38, v246
    v_sub_f32 v39, v39, v246
    v_sub_f32 v52, v52, v246
    v_sub_f32 v53, v53, v246
    v_sub_f32 v54, v54, v246
    v_sub_f32 v55, v55, v246
    v_sub_f32 v196, v196, v246
    v_sub_f32 v197, v197, v246
    v_sub_f32 v198, v198, v246
    v_sub_f32 v199, v199, v246
    v_mul_f32 v212, v225, v247
    v_mov_b32 v213, 0
    v_mov_b32 v214, 0
    v_mov_b32 v215, 0
    v_accvgpr_read_b32 v228, a32
    v_accvgpr_read_b32 v229, a33
    v_accvgpr_read_b32 v230, a34
    v_accvgpr_read_b32 v231, a35
    v_mul_f32 v228, v228, v247
    v_mul_f32 v229, v229, v247
    v_mul_f32 v230, v230, v247
    v_mul_f32 v231, v231, v247
    v_accvgpr_write_b32 a32, v228
    v_accvgpr_write_b32 a33, v229
    v_accvgpr_write_b32 a34, v230
    v_accvgpr_write_b32 a35, v231
    v_accvgpr_read_b32 v228, a36
    v_accvgpr_read_b32 v229, a37
    v_accvgpr_read_b32 v230, a38
    v_accvgpr_read_b32 v231, a39
    v_mul_f32 v228, v228, v247
    v_mul_f32 v229, v229, v247
    v_mul_f32 v230, v230, v247
    v_mul_f32 v231, v231, v247
    v_accvgpr_write_b32 a36, v228
    v_accvgpr_write_b32 a37, v229
    v_accvgpr_write_b32 a38, v230
    v_accvgpr_write_b32 a39, v231
    v_accvgpr_read_b32 v228, a40
    v_accvgpr_read_b32 v229, a41
    v_accvgpr_read_b32 v230, a42
    v_accvgpr_read_b32 v231, a43
    v_mul_f32 v228, v228, v247
    v_mul_f32 v229, v229, v247
    v_mul_f32 v230, v230, v247
    v_mul_f32 v231, v231, v247
    v_accvgpr_write_b32 a40, v228
    v_accvgpr_write_b32 a41, v229
    v_accvgpr_write_b32 a42, v230
    v_accvgpr_write_b32 a43, v231
    v_accvgpr_read_b32 v228, a44
    v_accvgpr_read_b32 v229, a45
    v_accvgpr_read_b32 v230, a46
    v_accvgpr_read_b32 v231, a47
    v_mul_f32 v228, v228, v247
    v_mul_f32 v229, v229, v247
    v_mul_f32 v230, v230, v247
    v_mul_f32 v231, v231, v247
    v_accvgpr_write_b32 a44, v228
    v_accvgpr_write_b32 a45, v229
    v_accvgpr_write_b32 a46, v230
    v_accvgpr_write_b32 a47, v231
    v_accvgpr_read_b32 v228, a48
    v_accvgpr_read_b32 v229, a49
    v_accvgpr_read_b32 v230, a50
    v_accvgpr_read_b32 v231, a51
    v_mul_f32 v228, v228, v247
    v_mul_f32 v229, v229, v247
    v_mul_f32 v230, v230, v247
    v_mul_f32 v231, v231, v247
    v_accvgpr_write_b32 a48, v228
    v_accvgpr_write_b32 a49, v229
    v_accvgpr_write_b32 a50, v230
    v_accvgpr_write_b32 a51, v231
    v_accvgpr_read_b32 v228, a52
    v_accvgpr_read_b32 v229, a53
    v_accvgpr_read_b32 v230, a54
    v_accvgpr_read_b32 v231, a55
    v_mul_f32 v228, v228, v247
    v_mul_f32 v229, v229, v247
    v_mul_f32 v230, v230, v247
    v_mul_f32 v231, v231, v247
    v_accvgpr_write_b32 a52, v228
    v_accvgpr_write_b32 a53, v229
    v_accvgpr_write_b32 a54, v230
    v_accvgpr_write_b32 a55, v231
    v_accvgpr_read_b32 v228, a56
    v_accvgpr_read_b32 v229, a57
    v_accvgpr_read_b32 v230, a58
    v_accvgpr_read_b32 v231, a59
    v_mul_f32 v228, v228, v247
    v_mul_f32 v229, v229, v247
    v_mul_f32 v230, v230, v247
    v_mul_f32 v231, v231, v247
    v_accvgpr_write_b32 a56, v228
    v_accvgpr_write_b32 a57, v229
    v_accvgpr_write_b32 a58, v230
    v_accvgpr_write_b32 a59, v231
    v_accvgpr_read_b32 v228, a60
    v_accvgpr_read_b32 v229, a61
    v_accvgpr_read_b32 v230, a62
    v_accvgpr_read_b32 v231, a63
    v_mul_f32 v228, v228, v247
    v_mul_f32 v229, v229, v247
    v_mul_f32 v230, v230, v247
    v_mul_f32 v231, v231, v247
    v_accvgpr_write_b32 a60, v228
    v_accvgpr_write_b32 a61, v229
    v_accvgpr_write_b32 a62, v230
    v_accvgpr_write_b32 a63, v231
    v_max3_f32 v246, v72, v73, 0
    v_max3_f32 v246, v246, v74, v75
    v_max3_f32 v246, v246, v88, v89
    v_max3_f32 v246, v246, v90, v91
    v_max3_f32 v246, v246, v104, v105
    v_max3_f32 v246, v246, v106, v107
    v_max3_f32 v246, v246, v120, v121
    v_max3_f32 v246, v246, v122, v123
    v_mov_b32 v247, v246
    s_nop 1
    v_permlane32_swap_b32 v246, v247
    s_nop 1
    v_max_f32 v246, v246, v247
    v_mov_b32 v247, v246
    s_nop 1
    v_permlane16_swap_b32 v246, v247
    s_nop 1
    v_max_f32 v246, v246, v247
    v_exp_f32 v247, -v246
    v_sub_f32 v72, v72, v246
    v_sub_f32 v73, v73, v246
    v_sub_f32 v74, v74, v246
    v_sub_f32 v75, v75, v246
    v_sub_f32 v88, v88, v246
    v_sub_f32 v89, v89, v246
    v_sub_f32 v90, v90, v246
    v_sub_f32 v91, v91, v246
    v_sub_f32 v104, v104, v246
    v_sub_f32 v105, v105, v246
    v_sub_f32 v106, v106, v246
    v_sub_f32 v107, v107, v246
    v_sub_f32 v120, v120, v246
    v_sub_f32 v121, v121, v246
    v_sub_f32 v122, v122, v246
    v_sub_f32 v123, v123, v246
    v_sub_f32 v8, v8, v246
    v_sub_f32 v9, v9, v246
    v_sub_f32 v10, v10, v246
    v_sub_f32 v11, v11, v246
    v_sub_f32 v24, v24, v246
    v_sub_f32 v25, v25, v246
    v_sub_f32 v26, v26, v246
    v_sub_f32 v27, v27, v246
    v_sub_f32 v40, v40, v246
    v_sub_f32 v41, v41, v246
    v_sub_f32 v42, v42, v246
    v_sub_f32 v43, v43, v246
    v_sub_f32 v56, v56, v246
    v_sub_f32 v57, v57, v246
    v_sub_f32 v58, v58, v246
    v_sub_f32 v59, v59, v246
    v_sub_f32 v200, v200, v246
    v_sub_f32 v201, v201, v246
    v_sub_f32 v202, v202, v246
    v_sub_f32 v203, v203, v246
    v_mul_f32 v216, v226, v247
    v_mov_b32 v217, 0
    v_mov_b32 v218, 0
    v_mov_b32 v219, 0
    v_accvgpr_read_b32 v228, a64
    v_accvgpr_read_b32 v229, a65
    v_accvgpr_read_b32 v230, a66
    v_accvgpr_read_b32 v231, a67
    v_mul_f32 v228, v228, v247
    v_mul_f32 v229, v229, v247
    v_mul_f32 v230, v230, v247
    v_mul_f32 v231, v231, v247
    v_accvgpr_write_b32 a64, v228
    v_accvgpr_write_b32 a65, v229
    v_accvgpr_write_b32 a66, v230
    v_accvgpr_write_b32 a67, v231
    v_accvgpr_read_b32 v228, a68
    v_accvgpr_read_b32 v229, a69
    v_accvgpr_read_b32 v230, a70
    v_accvgpr_read_b32 v231, a71
    v_mul_f32 v228, v228, v247
    v_mul_f32 v229, v229, v247
    v_mul_f32 v230, v230, v247
    v_mul_f32 v231, v231, v247
    v_accvgpr_write_b32 a68, v228
    v_accvgpr_write_b32 a69, v229
    v_accvgpr_write_b32 a70, v230
    v_accvgpr_write_b32 a71, v231
    v_accvgpr_read_b32 v228, a72
    v_accvgpr_read_b32 v229, a73
    v_accvgpr_read_b32 v230, a74
    v_accvgpr_read_b32 v231, a75
    v_mul_f32 v228, v228, v247
    v_mul_f32 v229, v229, v247
    v_mul_f32 v230, v230, v247
    v_mul_f32 v231, v231, v247
    v_accvgpr_write_b32 a72, v228
    v_accvgpr_write_b32 a73, v229
    v_accvgpr_write_b32 a74, v230
    v_accvgpr_write_b32 a75, v231
    v_accvgpr_read_b32 v228, a76
    v_accvgpr_read_b32 v229, a77
    v_accvgpr_read_b32 v230, a78
    v_accvgpr_read_b32 v231, a79
    v_mul_f32 v228, v228, v247
    v_mul_f32 v229, v229, v247
    v_mul_f32 v230, v230, v247
    v_mul_f32 v231, v231, v247
    v_accvgpr_write_b32 a76, v228
    v_accvgpr_write_b32 a77, v229
    v_accvgpr_write_b32 a78, v230
    v_accvgpr_write_b32 a79, v231
    v_accvgpr_read_b32 v228, a80
    v_accvgpr_read_b32 v229, a81
    v_accvgpr_read_b32 v230, a82
    v_accvgpr_read_b32 v231, a83
    v_mul_f32 v228, v228, v247
    v_mul_f32 v229, v229, v247
    v_mul_f32 v230, v230, v247
    v_mul_f32 v231, v231, v247
    v_accvgpr_write_b32 a80, v228
    v_accvgpr_write_b32 a81, v229
    v_accvgpr_write_b32 a82, v230
    v_accvgpr_write_b32 a83, v231
    v_accvgpr_read_b32 v228, a84
    v_accvgpr_read_b32 v229, a85
    v_accvgpr_read_b32 v230, a86
    v_accvgpr_read_b32 v231, a87
    v_mul_f32 v228, v228, v247
    v_mul_f32 v229, v229, v247
    v_mul_f32 v230, v230, v247
    v_mul_f32 v231, v231, v247
    v_accvgpr_write_b32 a84, v228
    v_accvgpr_write_b32 a85, v229
    v_accvgpr_write_b32 a86, v230
    v_accvgpr_write_b32 a87, v231
    v_accvgpr_read_b32 v228, a88
    v_accvgpr_read_b32 v229, a89
    v_accvgpr_read_b32 v230, a90
    v_accvgpr_read_b32 v231, a91
    v_mul_f32 v228, v228, v247
    v_mul_f32 v229, v229, v247
    v_mul_f32 v230, v230, v247
    v_mul_f32 v231, v231, v247
    v_accvgpr_write_b32 a88, v228
    v_accvgpr_write_b32 a89, v229
    v_accvgpr_write_b32 a90, v230
    v_accvgpr_write_b32 a91, v231
    v_accvgpr_read_b32 v228, a92
    v_accvgpr_read_b32 v229, a93
    v_accvgpr_read_b32 v230, a94
    v_accvgpr_read_b32 v231, a95
    v_mul_f32 v228, v228, v247
    v_mul_f32 v229, v229, v247
    v_mul_f32 v230, v230, v247
    v_mul_f32 v231, v231, v247
    v_accvgpr_write_b32 a92, v228
    v_accvgpr_write_b32 a93, v229
    v_accvgpr_write_b32 a94, v230
    v_accvgpr_write_b32 a95, v231
    v_max3_f32 v246, v76, v77, 0
    v_max3_f32 v246, v246, v78, v79
    v_max3_f32 v246, v246, v92, v93
    v_max3_f32 v246, v246, v94, v95
    v_max3_f32 v246, v246, v108, v109
    v_max3_f32 v246, v246, v110, v111
    v_max3_f32 v246, v246, v124, v125
    v_max3_f32 v246, v246, v126, v127
    v_mov_b32 v247, v246
    s_nop 1
    v_permlane32_swap_b32 v246, v247
    s_nop 1
    v_max_f32 v246, v246, v247
    v_mov_b32 v247, v246
    s_nop 1
    v_permlane16_swap_b32 v246, v247
    s_nop 1
    v_max_f32 v246, v246, v247
    v_exp_f32 v247, -v246
    v_sub_f32 v76, v76, v246
    v_sub_f32 v77, v77, v246
    v_sub_f32 v78, v78, v246
    v_sub_f32 v79, v79, v246
    v_sub_f32 v92, v92, v246
    v_sub_f32 v93, v93, v246
    v_sub_f32 v94, v94, v246
    v_sub_f32 v95, v95, v246
    v_sub_f32 v108, v108, v246
    v_sub_f32 v109, v109, v246
    v_sub_f32 v110, v110, v246
    v_sub_f32 v111, v111, v246
    v_sub_f32 v124, v124, v246
    v_sub_f32 v125, v125, v246
    v_sub_f32 v126, v126, v246
    v_sub_f32 v127, v127, v246
    v_sub_f32 v12, v12, v246
    v_sub_f32 v13, v13, v246
    v_sub_f32 v14, v14, v246
    v_sub_f32 v15, v15, v246
    v_sub_f32 v28, v28, v246
    v_sub_f32 v29, v29, v246
    v_sub_f32 v30, v30, v246
    v_sub_f32 v31, v31, v246
    v_sub_f32 v44, v44, v246
    v_sub_f32 v45, v45, v246
    v_sub_f32 v46, v46, v246
    v_sub_f32 v47, v47, v246
    v_sub_f32 v60, v60, v246
    v_sub_f32 v61, v61, v246
    v_sub_f32 v62, v62, v246
    v_sub_f32 v63, v63, v246
    v_sub_f32 v204, v204, v246
    v_sub_f32 v205, v205, v246
    v_sub_f32 v206, v206, v246
    v_sub_f32 v207, v207, v246
    v_mul_f32 v220, v227, v247
    v_mov_b32 v221, 0
    v_mov_b32 v222, 0
    v_mov_b32 v223, 0
    v_accvgpr_read_b32 v228, a96
    v_accvgpr_read_b32 v229, a97
    v_accvgpr_read_b32 v230, a98
    v_accvgpr_read_b32 v231, a99
    v_mul_f32 v228, v228, v247
    v_mul_f32 v229, v229, v247
    v_mul_f32 v230, v230, v247
    v_mul_f32 v231, v231, v247
    v_accvgpr_write_b32 a96, v228
    v_accvgpr_write_b32 a97, v229
    v_accvgpr_write_b32 a98, v230
    v_accvgpr_write_b32 a99, v231
    v_accvgpr_read_b32 v228, a100
    v_accvgpr_read_b32 v229, a101
    v_accvgpr_read_b32 v230, a102
    v_accvgpr_read_b32 v231, a103
    v_mul_f32 v228, v228, v247
    v_mul_f32 v229, v229, v247
    v_mul_f32 v230, v230, v247
    v_mul_f32 v231, v231, v247
    v_accvgpr_write_b32 a100, v228
    v_accvgpr_write_b32 a101, v229
    v_accvgpr_write_b32 a102, v230
    v_accvgpr_write_b32 a103, v231
    v_accvgpr_read_b32 v228, a104
    v_accvgpr_read_b32 v229, a105
    v_accvgpr_read_b32 v230, a106
    v_accvgpr_read_b32 v231, a107
    v_mul_f32 v228, v228, v247
    v_mul_f32 v229, v229, v247
    v_mul_f32 v230, v230, v247
    v_mul_f32 v231, v231, v247
    v_accvgpr_write_b32 a104, v228
    v_accvgpr_write_b32 a105, v229
    v_accvgpr_write_b32 a106, v230
    v_accvgpr_write_b32 a107, v231
    v_accvgpr_read_b32 v228, a108
    v_accvgpr_read_b32 v229, a109
    v_accvgpr_read_b32 v230, a110
    v_accvgpr_read_b32 v231, a111
    v_mul_f32 v228, v228, v247
    v_mul_f32 v229, v229, v247
    v_mul_f32 v230, v230, v247
    v_mul_f32 v231, v231, v247
    v_accvgpr_write_b32 a108, v228
    v_accvgpr_write_b32 a109, v229
    v_accvgpr_write_b32 a110, v230
    v_accvgpr_write_b32 a111, v231
    v_accvgpr_read_b32 v228, a112
    v_accvgpr_read_b32 v229, a113
    v_accvgpr_read_b32 v230, a114
    v_accvgpr_read_b32 v231, a115
    v_mul_f32 v228, v228, v247
    v_mul_f32 v229, v229, v247
    v_mul_f32 v230, v230, v247
    v_mul_f32 v231, v231, v247
    v_accvgpr_write_b32 a112, v228
    v_accvgpr_write_b32 a113, v229
    v_accvgpr_write_b32 a114, v230
    v_accvgpr_write_b32 a115, v231
    v_accvgpr_read_b32 v228, a116
    v_accvgpr_read_b32 v229, a117
    v_accvgpr_read_b32 v230, a118
    v_accvgpr_read_b32 v231, a119
    v_mul_f32 v228, v228, v247
    v_mul_f32 v229, v229, v247
    v_mul_f32 v230, v230, v247
    v_mul_f32 v231, v231, v247
    v_accvgpr_write_b32 a116, v228
    v_accvgpr_write_b32 a117, v229
    v_accvgpr_write_b32 a118, v230
    v_accvgpr_write_b32 a119, v231
    v_accvgpr_read_b32 v228, a120
    v_accvgpr_read_b32 v229, a121
    v_accvgpr_read_b32 v230, a122
    v_accvgpr_read_b32 v231, a123
    v_mul_f32 v228, v228, v247
    v_mul_f32 v229, v229, v247
    v_mul_f32 v230, v230, v247
    v_mul_f32 v231, v231, v247
    v_accvgpr_write_b32 a120, v228
    v_accvgpr_write_b32 a121, v229
    v_accvgpr_write_b32 a122, v230
    v_accvgpr_write_b32 a123, v231
    v_accvgpr_read_b32 v228, a124
    v_accvgpr_read_b32 v229, a125
    v_accvgpr_read_b32 v230, a126
    v_accvgpr_read_b32 v231, a127
    v_mul_f32 v228, v228, v247
    v_mul_f32 v229, v229, v247
    v_mul_f32 v230, v230, v247
    v_mul_f32 v231, v231, v247
    v_accvgpr_write_b32 a124, v228
    v_accvgpr_write_b32 a125, v229
    v_accvgpr_write_b32 a126, v230
    v_accvgpr_write_b32 a127, v231
    v_exp_f32 v228, v64
    v_exp_f32 v229, v65
    v_exp_f32 v230, v66
    v_exp_f32 v231, v67
    v_exp_f32 v232, v80
    v_exp_f32 v233, v81
    v_exp_f32 v234, v82
    v_exp_f32 v235, v83
    s_nop 0
    v_cvt_pk_bf16_f32 v160, v228, v229
    v_cvt_pk_bf16_f32 v161, v230, v231
    v_cvt_pk_bf16_f32 v162, v232, v233
    v_cvt_pk_bf16_f32 v163, v234, v235
    v_exp_f32 v228, v96
    v_exp_f32 v229, v97
    v_exp_f32 v230, v98
    v_exp_f32 v231, v99
    v_exp_f32 v232, v112
    v_exp_f32 v233, v113
    v_exp_f32 v234, v114
    v_exp_f32 v235, v115
    s_nop 0
    v_cvt_pk_bf16_f32 v164, v228, v229
    v_cvt_pk_bf16_f32 v165, v230, v231
    v_cvt_pk_bf16_f32 v166, v232, v233
    v_cvt_pk_bf16_f32 v167, v234, v235
    s_nop 1
    v_smfmac_f32_16x16x64_bf16 v[208:211], v[236:239], v[160:167], v245
    v_exp_f32 v228, v68
    v_exp_f32 v229, v69
    v_exp_f32 v230, v70
    v_exp_f32 v231, v71
    v_exp_f32 v232, v84
    v_exp_f32 v233, v85
    v_exp_f32 v234, v86
    v_exp_f32 v235, v87
    s_nop 0
    v_cvt_pk_bf16_f32 v168, v228, v229
    v_cvt_pk_bf16_f32 v169, v230, v231
    v_cvt_pk_bf16_f32 v170, v232, v233
    v_cvt_pk_bf16_f32 v171, v234, v235
    v_exp_f32 v228, v100
    v_exp_f32 v229, v101
    v_exp_f32 v230, v102
    v_exp_f32 v231, v103
    v_exp_f32 v232, v116
    v_exp_f32 v233, v117
    v_exp_f32 v234, v118
    v_exp_f32 v235, v119
    s_nop 0
    v_cvt_pk_bf16_f32 v172, v228, v229
    v_cvt_pk_bf16_f32 v173, v230, v231
    v_cvt_pk_bf16_f32 v174, v232, v233
    v_cvt_pk_bf16_f32 v175, v234, v235
    s_nop 1
    v_smfmac_f32_16x16x64_bf16 v[212:215], v[236:239], v[168:175], v245
    v_exp_f32 v228, v72
    v_exp_f32 v229, v73
    v_exp_f32 v230, v74
    v_exp_f32 v231, v75
    v_exp_f32 v232, v88
    v_exp_f32 v233, v89
    v_exp_f32 v234, v90
    v_exp_f32 v235, v91
    s_nop 0
    v_cvt_pk_bf16_f32 v176, v228, v229
    v_cvt_pk_bf16_f32 v177, v230, v231
    v_cvt_pk_bf16_f32 v178, v232, v233
    v_cvt_pk_bf16_f32 v179, v234, v235
    v_exp_f32 v228, v104
    v_exp_f32 v229, v105
    v_exp_f32 v230, v106
    v_exp_f32 v231, v107
    v_exp_f32 v232, v120
    v_exp_f32 v233, v121
    v_exp_f32 v234, v122
    v_exp_f32 v235, v123
    s_nop 0
    v_cvt_pk_bf16_f32 v180, v228, v229
    v_cvt_pk_bf16_f32 v181, v230, v231
    v_cvt_pk_bf16_f32 v182, v232, v233
    v_cvt_pk_bf16_f32 v183, v234, v235
    s_nop 1
    v_smfmac_f32_16x16x64_bf16 v[216:219], v[236:239], v[176:183], v245
    v_exp_f32 v228, v76
    v_exp_f32 v229, v77
    v_exp_f32 v230, v78
    v_exp_f32 v231, v79
    v_exp_f32 v232, v92
    v_exp_f32 v233, v93
    v_exp_f32 v234, v94
    v_exp_f32 v235, v95
    s_nop 0
    v_cvt_pk_bf16_f32 v184, v228, v229
    v_cvt_pk_bf16_f32 v185, v230, v231
    v_cvt_pk_bf16_f32 v186, v232, v233
    v_cvt_pk_bf16_f32 v187, v234, v235
    v_exp_f32 v228, v108
    v_exp_f32 v229, v109
    v_exp_f32 v230, v110
    v_exp_f32 v231, v111
    v_exp_f32 v232, v124
    v_exp_f32 v233, v125
    v_exp_f32 v234, v126
    v_exp_f32 v235, v127
    s_nop 0
    v_cvt_pk_bf16_f32 v188, v228, v229
    v_cvt_pk_bf16_f32 v189, v230, v231
    v_cvt_pk_bf16_f32 v190, v232, v233
    v_cvt_pk_bf16_f32 v191, v234, v235
    s_nop 1
    v_smfmac_f32_16x16x64_bf16 v[220:223], v[236:239], v[184:191], v245
    s_nop 7
    s_nop 7
    v_add_f32 v248, v208, v209
    v_add_f32 v249, v212, v213
    v_add_f32 v250, v216, v217
    v_add_f32 v251, v220, v221
    s_cmp_eq_u32 s29, 0
    s_cbranch_scc1 L_r1
    s_cmp_eq_u32 s29, 1
    s_cbranch_scc1 L_r3
    s_cmp_eq_u32 s29, 2
    s_cbranch_scc1 L_ret1
    s_branch L_ret3
.section .rodata,"a"
.p2align 6
.amdhsa_kernel standalone__gqa_softmax__near_ridge_kernel
  .amdhsa_next_free_vgpr 512
  .amdhsa_next_free_sgpr 72
  .amdhsa_accum_offset 256
  .amdhsa_group_segment_fixed_size 0
  .amdhsa_kernarg_size 48
  .amdhsa_user_sgpr_count 2
  .amdhsa_user_sgpr_kernarg_segment_ptr 1
  .amdhsa_system_sgpr_workgroup_id_x 1
  .amdhsa_float_denorm_mode_32 3
.end_amdhsa_kernel
```
